```python
import torch

def _softmax(x, axis=-1):
    return torch.softmax(x, dim=axis)
def _gelu(x):
    return torch.nn.functional.gelu(x, approximate="tanh")
def _silu(x):
    return torch.nn.functional.silu(x)
def _sigmoid(x):
    return torch.sigmoid(x)
def _layernorm(x, axis=-1, eps=1e-5):
    m = x.mean(dim=axis, keepdim=True)
    v = x.var(dim=axis, keepdim=True, unbiased=False)
    return (x - m) / torch.sqrt(v + eps)
def _scatter_add(tgt, idx, src, axis=0):
    return tgt.clone().index_add_(axis, idx, src)
def _segment_sum(src, seg, n):
    out = torch.zeros((n,) + src.shape[1:], dtype=src.dtype)
    return out.index_add_(0, seg, src)
def _pad(x, pw):
    flat = tuple(v for pair in reversed(pw) for v in pair)
    return torch.nn.functional.pad(x, flat)

kernel_name = 'standalone__linear_kernel_rfa__decode'

def setup_inputs():

    _w = (lambda a: (lambda t: t.to(torch.bfloat16) if t.is_floating_point() else t)(torch.as_tensor(a)))
    B, H, Sq, Sk, D, M = 2, 32, 1, 4096, 128, 8
    return {
        "q": _w((lambda *s: torch.randn(*s, dtype=torch.bfloat16) * 0.4)(B, H, Sq, D)),
        "k": _w((lambda *s: torch.randn(*s, dtype=torch.bfloat16) * 1.6)(B, H, Sk, D)),
        "v": _w((lambda *s: torch.randn(*s, dtype=torch.bfloat16) * 1.6)(B, H, Sk, D)),
        "omega": _w((lambda *s: torch.randn(*s, dtype=torch.bfloat16) * 1.6)(M, D)),
    }

def reference(q, k, v, omega):
    d = q.shape[-1]
    m = omega.shape[0]
    scale = float(d) ** -0.25
    qs = q * scale
    ks = k * scale
    q_proj = torch.einsum("bhsd,md->bhsm", qs, omega)
    k_proj = torch.einsum("bhsd,md->bhsm", ks, omega)
    q_sq = 0.5 * torch.einsum("bhsd,bhsd->bhs", qs, qs)[..., None]
    k_sq = 0.5 * torch.einsum("bhsd,bhsd->bhs", ks, ks)[..., None]
    inv_sqrt_m = float(m) ** -0.5
    phi_q = torch.exp(q_proj - q_sq) * inv_sqrt_m + 1e-6
    phi_k = torch.exp(k_proj - k_sq) * inv_sqrt_m + 1e-6
    kv = torch.einsum("bhsm,bhsd->bhmd", phi_k, v)
    z  = torch.einsum("bhsm->bhm", phi_k)
    num = torch.einsum("bhqm,bhmd->bhqd", phi_q, kv)
    den = torch.einsum("bhqm,bhm->bhq", phi_q, z)[..., None] + 1e-6
    return num / den
```

```asm
; @launch grid=(256,1,1) block=(512,1,1) lds=33040
.amdgcn_target "amdgcn-amd-amdhsa--gfx950"
.text
.globl standalone__linear_kernel_rfa__decode_kernel
.p2align 8
.type standalone__linear_kernel_rfa__decode_kernel,@function
standalone__linear_kernel_rfa__decode_kernel:
    s_cmp_ge_u32 s2, 256
    s_cbranch_scc1 L_end
    s_load_dwordx8 s[4:11], s[0:1], 0
    s_load_dwordx4 s[12:15], s[0:1], 32
    s_load_dwordx2 s[16:17], s[0:1], 48
    s_memrealtime s[18:19]
    v_and_b32 v1, 63, v0
    v_lshrrev_b32 v4, 6, v0
    s_nop 0
    v_readfirstlane_b32 s48, v4
    v_bfe_u32 v103, v1, 3, 1
    v_lshlrev_b32 v103, 6, v103
    v_lshrrev_b32 v102, 4, v1
    v_lshl_add_u32 v102, v102, 4, v103
    v_and_b32 v100, 3, v1
    v_lshlrev_b32 v100, 11, v100
    v_bfe_u32 v101, v1, 2, 1
    v_lshlrev_b32 v101, 8, v101
    v_add3_u32 v2, v100, v101, v102
    v_lshlrev_b32 v3, 4, v1
    v_and_b32 v103, 7, v1
    v_lshl_add_u32 v103, v103, 8, v102
    s_lshr_b32 s49, s2, 2
    s_and_b32 s50, s2, 3
    s_lshl_b32 s3, s48, 13
    s_add_u32 s64, s3, 0
    s_add_u32 s68, s3, 4096
    s_add_u32 s65, s3, 65536
    s_add_u32 s69, s3, 69632
    s_add_u32 s66, s3, 131072
    s_add_u32 s70, s3, 135168
    s_add_u32 s67, s3, 196608
    s_add_u32 s71, s3, 200704
    s_lshl_b32 s3, s2, 18
    s_waitcnt lgkmcnt(0)
    s_add_u32 s20, s6, s3
    s_addc_u32 s21, s7, 0
    s_mov_b32 s22, 0x40000
    s_mov_b32 s23, 0x20000
    buffer_load_dwordx4 v[128:131], v2, s[20:23], s64 offen offset:0 nt
    buffer_load_dwordx4 v[132:135], v2, s[20:23], s64 offen offset:128 nt
    buffer_load_dwordx4 v[136:139], v2, s[20:23], s64 offen offset:512 nt
    buffer_load_dwordx4 v[140:143], v2, s[20:23], s64 offen offset:640 nt
    buffer_load_dwordx4 v[144:147], v2, s[20:23], s64 offen offset:1024 nt
    buffer_load_dwordx4 v[148:151], v2, s[20:23], s64 offen offset:1152 nt
    buffer_load_dwordx4 v[152:155], v2, s[20:23], s64 offen offset:1536 nt
    buffer_load_dwordx4 v[156:159], v2, s[20:23], s64 offen offset:1664 nt
    s_add_u32 s24, s8, s3
    s_addc_u32 s25, s9, 0
    s_mov_b32 s26, 0x40000
    s_mov_b32 s27, 0x20000
    s_mov_b32 s28, s10
    s_mov_b32 s29, s11
    s_mov_b32 s30, 2048
    s_mov_b32 s31, 0x20000
    s_lshl_b32 s3, s49, 8
    s_add_u32 s32, s4, s3
    s_addc_u32 s33, s5, 0
    s_mov_b32 s34, 256
    s_mov_b32 s35, 0x20000
    buffer_load_dwordx4 v[12:15], v103, s[28:31], 0 offen offset:0
    buffer_load_dwordx4 v[16:19], v103, s[28:31], 0 offen offset:128
    buffer_load_dwordx4 v[108:111], v102, s[32:35], 0 offen offset:0
    buffer_load_dwordx4 v[112:115], v102, s[32:35], 0 offen offset:128
    buffer_load_dwordx4 v[116:119], v102, s[32:35], 0 offen offset:0
    buffer_load_dwordx4 v[120:123], v102, s[32:35], 0 offen offset:128
    buffer_load_dwordx4 v[160:163], v2, s[20:23], s65 offen offset:0 nt
    buffer_load_dwordx4 v[164:167], v2, s[20:23], s65 offen offset:128 nt
    buffer_load_dwordx4 v[168:171], v2, s[20:23], s65 offen offset:512 nt
    buffer_load_dwordx4 v[172:175], v2, s[20:23], s65 offen offset:640 nt
    buffer_load_dwordx4 v[176:179], v2, s[20:23], s65 offen offset:1024 nt
    buffer_load_dwordx4 v[180:183], v2, s[20:23], s65 offen offset:1152 nt
    buffer_load_dwordx4 v[184:187], v2, s[20:23], s65 offen offset:1536 nt
    buffer_load_dwordx4 v[188:191], v2, s[20:23], s65 offen offset:1664 nt
    s_add_u32 s40, s12, s3
    s_addc_u32 s41, s13, 0
    s_mov_b32 s42, 256
    s_mov_b32 s43, 0x20000
    s_mov_b32 s44, s14
    s_mov_b32 s45, s15
    s_mov_b32 s46, 256
    s_mov_b32 s47, 0x20000
    s_lshl_b32 s3, s49, 16
    s_add_u32 s36, s16, s3
    s_addc_u32 s37, s17, 0
    s_mov_b32 s38, 0x10000
    s_mov_b32 s39, 0x20000
    s_lshl_b32 s51, s48, 11
    s_lshl_b32 s82, s50, 14
    s_add_u32 s82, s82, s51
    s_mov_b32 s52, 0x3e9837f0
    s_mov_b32 s53, 0x3e9837f0
    s_mov_b32 s54, 0x05040100
    s_mov_b32 s55, 0x07060302
    s_mov_b32 s56, 0x3fb8aa00
    s_mov_b32 s57, 0x36eca570
    s_mov_b32 s58, 0x3eb504f3
    s_mov_b32 s59, 0x358637bd
    s_mov_b32 s61, 0x43480000
    v_mov_b32 v6, 0xc3480000
    v_mov_b32 v5, 1.0
    v_mov_b32 v7, s18
    v_mov_b32 v0, s19
    v_mov_b32 v8, 0x3f803f80
    v_mov_b32 v9, 0x3f803f80
    v_mov_b32 v10, 0x3f803f80
    v_mov_b32 v11, 0x3f803f80
    v_mov_b32 v20, 0
    v_mov_b32 v21, 0
    v_mov_b32 v22, 0
    v_mov_b32 v23, 0
    v_mov_b32 v24, 0
    v_mov_b32 v25, 0
    v_mov_b32 v26, 0
    v_mov_b32 v27, 0
    v_mov_b32 v28, 0
    v_mov_b32 v29, 0
    v_mov_b32 v30, 0
    v_mov_b32 v31, 0
    v_mov_b32 v32, 0
    v_mov_b32 v33, 0
    v_mov_b32 v34, 0
    v_mov_b32 v35, 0
    v_mov_b32 v36, 0
    v_mov_b32 v37, 0
    v_mov_b32 v38, 0
    v_mov_b32 v39, 0
    v_mov_b32 v40, 0
    v_mov_b32 v41, 0
    v_mov_b32 v42, 0
    v_mov_b32 v43, 0
    v_mov_b32 v44, 0
    v_mov_b32 v45, 0
    v_mov_b32 v46, 0
    v_mov_b32 v47, 0
    v_mov_b32 v48, 0
    v_mov_b32 v49, 0
    v_mov_b32 v50, 0
    v_mov_b32 v51, 0
    v_mov_b32 v52, 0
    v_mov_b32 v53, 0
    v_mov_b32 v54, 0
    v_mov_b32 v55, 0
    s_waitcnt vmcnt(8)
    v_lshlrev_b32 v100, 16, v108
    v_and_b32 v101, 0xffff0000, v108
    v_lshlrev_b32 v102, 16, v109
    v_and_b32 v103, 0xffff0000, v109
    v_lshlrev_b32 v104, 16, v110
    v_and_b32 v105, 0xffff0000, v110
    v_lshlrev_b32 v106, 16, v111
    v_and_b32 v107, 0xffff0000, v111
    v_pk_mul_f32 v[100:101], v[100:101], s[52:53]
    v_pk_mul_f32 v[102:103], v[102:103], s[52:53]
    v_pk_mul_f32 v[104:105], v[104:105], s[52:53]
    v_pk_mul_f32 v[106:107], v[106:107], s[52:53]
    v_cvt_pk_bf16_f32 v108, v100, v101
    v_cvt_pk_bf16_f32 v109, v102, v103
    v_cvt_pk_bf16_f32 v110, v104, v105
    v_cvt_pk_bf16_f32 v111, v106, v107
    v_dot2_f32_bf16 v96, v108, v108, 0
    v_dot2_f32_bf16 v96, v109, v109, v96
    v_dot2_f32_bf16 v96, v110, v110, v96
    v_dot2_f32_bf16 v96, v111, v111, v96
    v_mfma_f32_16x16x32_bf16 v[72:75], v[108:111], v[12:15], 0
    v_lshlrev_b32 v100, 16, v112
    v_and_b32 v101, 0xffff0000, v112
    v_lshlrev_b32 v102, 16, v113
    v_and_b32 v103, 0xffff0000, v113
    v_lshlrev_b32 v104, 16, v114
    v_and_b32 v105, 0xffff0000, v114
    v_lshlrev_b32 v106, 16, v115
    v_and_b32 v107, 0xffff0000, v115
    v_pk_mul_f32 v[100:101], v[100:101], s[52:53]
    v_pk_mul_f32 v[102:103], v[102:103], s[52:53]
    v_pk_mul_f32 v[104:105], v[104:105], s[52:53]
    v_pk_mul_f32 v[106:107], v[106:107], s[52:53]
    v_cvt_pk_bf16_f32 v112, v100, v101
    v_cvt_pk_bf16_f32 v113, v102, v103
    v_cvt_pk_bf16_f32 v114, v104, v105
    v_cvt_pk_bf16_f32 v115, v106, v107
    v_dot2_f32_bf16 v96, v112, v112, v96
    v_dot2_f32_bf16 v96, v113, v113, v96
    v_dot2_f32_bf16 v96, v114, v114, v96
    v_dot2_f32_bf16 v96, v115, v115, v96
    v_mfma_f32_16x16x32_bf16 v[72:75], v[112:115], v[16:19], v[72:75]
    v_lshlrev_b32 v100, 16, v116
    v_and_b32 v101, 0xffff0000, v116
    v_lshlrev_b32 v102, 16, v117
    v_and_b32 v103, 0xffff0000, v117
    v_lshlrev_b32 v104, 16, v118
    v_and_b32 v105, 0xffff0000, v118
    v_lshlrev_b32 v106, 16, v119
    v_and_b32 v107, 0xffff0000, v119
    v_pk_mul_f32 v[100:101], v[100:101], s[52:53]
    v_pk_mul_f32 v[102:103], v[102:103], s[52:53]
    v_pk_mul_f32 v[104:105], v[104:105], s[52:53]
    v_pk_mul_f32 v[106:107], v[106:107], s[52:53]
    v_cvt_pk_bf16_f32 v116, v100, v101
    v_cvt_pk_bf16_f32 v117, v102, v103
    v_cvt_pk_bf16_f32 v118, v104, v105
    v_cvt_pk_bf16_f32 v119, v106, v107
    v_dot2_f32_bf16 v97, v116, v116, 0
    v_dot2_f32_bf16 v97, v117, v117, v97
    v_dot2_f32_bf16 v97, v118, v118, v97
    v_dot2_f32_bf16 v97, v119, v119, v97
    v_mfma_f32_16x16x32_bf16 v[76:79], v[116:119], v[12:15], 0
    v_lshlrev_b32 v100, 16, v120
    v_and_b32 v101, 0xffff0000, v120
    v_lshlrev_b32 v102, 16, v121
    v_and_b32 v103, 0xffff0000, v121
    v_lshlrev_b32 v104, 16, v122
    v_and_b32 v105, 0xffff0000, v122
    v_lshlrev_b32 v106, 16, v123
    v_and_b32 v107, 0xffff0000, v123
    v_pk_mul_f32 v[100:101], v[100:101], s[52:53]
    v_pk_mul_f32 v[102:103], v[102:103], s[52:53]
    v_pk_mul_f32 v[104:105], v[104:105], s[52:53]
    v_pk_mul_f32 v[106:107], v[106:107], s[52:53]
    v_cvt_pk_bf16_f32 v120, v100, v101
    v_cvt_pk_bf16_f32 v121, v102, v103
    v_cvt_pk_bf16_f32 v122, v104, v105
    v_cvt_pk_bf16_f32 v123, v106, v107
    v_dot2_f32_bf16 v97, v120, v120, v97
    v_dot2_f32_bf16 v97, v121, v121, v97
    v_dot2_f32_bf16 v97, v122, v122, v97
    v_dot2_f32_bf16 v97, v123, v123, v97
    v_mfma_f32_16x16x32_bf16 v[76:79], v[120:123], v[16:19], v[76:79]
    v_add_f32_dpp v96, v96, v96 row_ror:8 row_mask:0xf bank_mask:0xf
    s_nop 0
    v_add_f32_dpp v97, v97, v97 row_ror:8 row_mask:0xf bank_mask:0xf
    s_nop 1
    v_mov_b32_dpp v96, v97 quad_perm:[0,1,2,3] row_mask:0xf bank_mask:0xc
    s_nop 1
    v_mfma_f32_16x16x4_f32 v[88:91], v96, v5, 0
    v_permlane32_swap_b32 v72, v76
    v_permlane32_swap_b32 v73, v77
    v_permlane32_swap_b32 v74, v78
    v_permlane32_swap_b32 v75, v79
    v_add_f32_dpp v72, v76, v72 row_ror:8 row_mask:0xf bank_mask:0xf
    v_add_f32_dpp v73, v77, v73 row_ror:8 row_mask:0xf bank_mask:0xf
    v_add_f32_dpp v74, v78, v74 row_ror:8 row_mask:0xf bank_mask:0xf
    v_add_f32_dpp v75, v79, v75 row_ror:8 row_mask:0xf bank_mask:0xf
    v_cvt_pk_bf16_f32 v100, v72, v73
    v_cvt_pk_bf16_f32 v101, v74, v75
    v_lshlrev_b32 v72, 16, v100
    v_and_b32 v73, 0xffff0000, v100
    v_lshlrev_b32 v74, 16, v101
    v_and_b32 v75, 0xffff0000, v101
    v_cvt_pk_bf16_f32 v102, v88, v89
    v_cvt_pk_bf16_f32 v103, v90, v91
    v_lshlrev_b32 v88, 16, v102
    v_and_b32 v89, 0xffff0000, v102
    v_lshlrev_b32 v90, 16, v103
    v_and_b32 v91, 0xffff0000, v103
    v_fma_f32 v72, v88, -0.5, v72
    v_fma_f32 v73, v89, -0.5, v73
    v_fma_f32 v74, v90, -0.5, v74
    v_fma_f32 v75, v91, -0.5, v75
    v_cvt_pk_bf16_f32 v100, v72, v73
    v_cvt_pk_bf16_f32 v101, v74, v75
    v_lshlrev_b32 v72, 16, v100
    v_and_b32 v73, 0xffff0000, v100
    v_lshlrev_b32 v74, 16, v101
    v_and_b32 v75, 0xffff0000, v101
    v_med3_f32 v72, v72, v6, s61
    v_med3_f32 v73, v73, v6, s61
    v_med3_f32 v74, v74, v6, s61
    v_med3_f32 v75, v75, v6, s61
    v_mul_f32 v88, s56, v72
    v_mul_f32 v89, s56, v73
    v_mul_f32 v90, s56, v74
    v_mul_f32 v91, s56, v75
    v_rndne_f32 v100, v88
    v_rndne_f32 v101, v89
    v_rndne_f32 v102, v90
    v_rndne_f32 v103, v91
    v_sub_f32 v88, v88, v100
    v_sub_f32 v89, v89, v101
    v_sub_f32 v90, v90, v102
    v_sub_f32 v91, v91, v103
    v_fma_f32 v88, v72, s57, v88
    v_fma_f32 v89, v73, s57, v89
    v_fma_f32 v90, v74, s57, v90
    v_fma_f32 v91, v75, s57, v91
    v_cvt_i32_f32 v100, v100
    v_cvt_i32_f32 v101, v101
    v_cvt_i32_f32 v102, v102
    v_cvt_i32_f32 v103, v103
    v_exp_f32 v88, v88
    v_exp_f32 v89, v89
    v_exp_f32 v90, v90
    v_exp_f32 v91, v91
    v_ldexp_f32 v72, v88, v100
    v_ldexp_f32 v73, v89, v101
    v_ldexp_f32 v74, v90, v102
    v_ldexp_f32 v75, v91, v103
    v_cvt_pk_bf16_f32 v100, v72, v73
    v_cvt_pk_bf16_f32 v101, v74, v75
    v_lshlrev_b32 v72, 16, v100
    v_and_b32 v73, 0xffff0000, v100
    v_lshlrev_b32 v74, 16, v101
    v_and_b32 v75, 0xffff0000, v101
    v_mul_f32 v72, s58, v72
    v_mul_f32 v73, s58, v73
    v_mul_f32 v74, s58, v74
    v_mul_f32 v75, s58, v75
    v_cvt_pk_bf16_f32 v100, v72, v73
    v_cvt_pk_bf16_f32 v101, v74, v75
    v_lshlrev_b32 v72, 16, v100
    v_and_b32 v73, 0xffff0000, v100
    v_lshlrev_b32 v74, 16, v101
    v_and_b32 v75, 0xffff0000, v101
    v_add_f32 v72, s59, v72
    v_add_f32 v73, s59, v73
    v_add_f32 v74, s59, v74
    v_add_f32 v75, s59, v75
    v_cvt_pk_bf16_f32 v104, v72, v73
    v_cvt_pk_bf16_f32 v105, v74, v75
    v_lshlrev_b32 v104, 16, v104
    v_lshrrev_b32 v105, 5, v1
    v_lshlrev_b32 v105, 1, v105
    v_and_b32 v106, 1, v1
    v_add_u32 v105, v105, v106
    v_lshlrev_b32 v125, 3, v105
    v_add_u32 v106, 4, v125
    ds_bpermute_b32 v126, v125, v104
    ds_bpermute_b32 v127, v106, v104
    v_lshlrev_b32 v124, 3, v1
    v_lshlrev_b32 v4, 1, v125
    s_waitcnt lgkmcnt(0)
    s_waitcnt vmcnt(18)
    v_lshlrev_b32 v100, 16, v128
    v_and_b32 v101, 0xffff0000, v128
    v_lshlrev_b32 v102, 16, v129
    v_and_b32 v103, 0xffff0000, v129
    v_lshlrev_b32 v104, 16, v130
    v_and_b32 v105, 0xffff0000, v130
    v_lshlrev_b32 v106, 16, v131
    v_and_b32 v107, 0xffff0000, v131
    v_pk_mul_f32 v[100:101], v[100:101], s[52:53]
    v_pk_mul_f32 v[102:103], v[102:103], s[52:53]
    v_pk_mul_f32 v[104:105], v[104:105], s[52:53]
    v_pk_mul_f32 v[106:107], v[106:107], s[52:53]
    v_cvt_pk_bf16_f32 v128, v100, v101
    v_cvt_pk_bf16_f32 v129, v102, v103
    v_cvt_pk_bf16_f32 v130, v104, v105
    v_cvt_pk_bf16_f32 v131, v106, v107
    v_dot2_f32_bf16 v96, v128, v128, 0
    v_dot2_f32_bf16 v96, v129, v129, v96
    v_dot2_f32_bf16 v96, v130, v130, v96
    v_dot2_f32_bf16 v96, v131, v131, v96
    v_mfma_f32_16x16x32_bf16 v[72:75], v[128:131], v[12:15], 0
    v_lshlrev_b32 v100, 16, v132
    v_and_b32 v101, 0xffff0000, v132
    v_lshlrev_b32 v102, 16, v133
    v_and_b32 v103, 0xffff0000, v133
    v_lshlrev_b32 v104, 16, v134
    v_and_b32 v105, 0xffff0000, v134
    v_lshlrev_b32 v106, 16, v135
    v_and_b32 v107, 0xffff0000, v135
    v_pk_mul_f32 v[100:101], v[100:101], s[52:53]
    v_pk_mul_f32 v[102:103], v[102:103], s[52:53]
    v_pk_mul_f32 v[104:105], v[104:105], s[52:53]
    v_pk_mul_f32 v[106:107], v[106:107], s[52:53]
    v_cvt_pk_bf16_f32 v132, v100, v101
    v_cvt_pk_bf16_f32 v133, v102, v103
    v_cvt_pk_bf16_f32 v134, v104, v105
    v_cvt_pk_bf16_f32 v135, v106, v107
    v_dot2_f32_bf16 v96, v132, v132, v96
    v_dot2_f32_bf16 v96, v133, v133, v96
    v_dot2_f32_bf16 v96, v134, v134, v96
    v_dot2_f32_bf16 v96, v135, v135, v96
    v_mfma_f32_16x16x32_bf16 v[72:75], v[132:135], v[16:19], v[72:75]
    v_lshlrev_b32 v100, 16, v136
    v_and_b32 v101, 0xffff0000, v136
    v_lshlrev_b32 v102, 16, v137
    v_and_b32 v103, 0xffff0000, v137
    v_lshlrev_b32 v104, 16, v138
    v_and_b32 v105, 0xffff0000, v138
    v_lshlrev_b32 v106, 16, v139
    v_and_b32 v107, 0xffff0000, v139
    v_pk_mul_f32 v[100:101], v[100:101], s[52:53]
    v_pk_mul_f32 v[102:103], v[102:103], s[52:53]
    v_pk_mul_f32 v[104:105], v[104:105], s[52:53]
    v_pk_mul_f32 v[106:107], v[106:107], s[52:53]
    v_cvt_pk_bf16_f32 v136, v100, v101
    v_cvt_pk_bf16_f32 v137, v102, v103
    v_cvt_pk_bf16_f32 v138, v104, v105
    v_cvt_pk_bf16_f32 v139, v106, v107
    v_dot2_f32_bf16 v97, v136, v136, 0
    v_dot2_f32_bf16 v97, v137, v137, v97
    v_dot2_f32_bf16 v97, v138, v138, v97
    v_dot2_f32_bf16 v97, v139, v139, v97
    v_mfma_f32_16x16x32_bf16 v[76:79], v[136:139], v[12:15], 0
    v_lshlrev_b32 v100, 16, v140
    v_and_b32 v101, 0xffff0000, v140
    v_lshlrev_b32 v102, 16, v141
    v_and_b32 v103, 0xffff0000, v141
    v_lshlrev_b32 v104, 16, v142
    v_and_b32 v105, 0xffff0000, v142
    v_lshlrev_b32 v106, 16, v143
    v_and_b32 v107, 0xffff0000, v143
    v_pk_mul_f32 v[100:101], v[100:101], s[52:53]
    v_pk_mul_f32 v[102:103], v[102:103], s[52:53]
    v_pk_mul_f32 v[104:105], v[104:105], s[52:53]
    v_pk_mul_f32 v[106:107], v[106:107], s[52:53]
    v_cvt_pk_bf16_f32 v140, v100, v101
    v_cvt_pk_bf16_f32 v141, v102, v103
    v_cvt_pk_bf16_f32 v142, v104, v105
    v_cvt_pk_bf16_f32 v143, v106, v107
    v_dot2_f32_bf16 v97, v140, v140, v97
    v_dot2_f32_bf16 v97, v141, v141, v97
    v_dot2_f32_bf16 v97, v142, v142, v97
    v_dot2_f32_bf16 v97, v143, v143, v97
    v_mfma_f32_16x16x32_bf16 v[76:79], v[140:143], v[16:19], v[76:79]
    v_add_f32_dpp v96, v96, v96 row_ror:8 row_mask:0xf bank_mask:0xf
    s_nop 0
    v_add_f32_dpp v97, v97, v97 row_ror:8 row_mask:0xf bank_mask:0xf
    s_nop 1
    v_mov_b32_dpp v96, v97 quad_perm:[0,1,2,3] row_mask:0xf bank_mask:0xc
    s_nop 1
    v_mfma_f32_16x16x4_f32 v[88:91], v96, v5, 0
    s_waitcnt vmcnt(14)
    buffer_load_dwordx4 v[192:195], v3, s[24:27], s64 offen offset:0 nt
    buffer_load_dwordx4 v[196:199], v3, s[24:27], s64 offen offset:2048 nt
    buffer_load_dwordx4 v[200:203], v3, s[24:27], s68 offen offset:0 nt
    buffer_load_dwordx4 v[204:207], v3, s[24:27], s68 offen offset:2048 nt
    buffer_load_dwordx4 v[208:211], v3, s[24:27], s64 offen offset:1024 nt
    buffer_load_dwordx4 v[212:215], v3, s[24:27], s64 offen offset:3072 nt
    buffer_load_dwordx4 v[216:219], v3, s[24:27], s68 offen offset:1024 nt
    buffer_load_dwordx4 v[220:223], v3, s[24:27], s68 offen offset:3072 nt
    v_lshlrev_b32 v108, 16, v144
    v_and_b32 v109, 0xffff0000, v144
    v_lshlrev_b32 v110, 16, v145
    v_and_b32 v111, 0xffff0000, v145
    v_lshlrev_b32 v112, 16, v146
    v_and_b32 v113, 0xffff0000, v146
    v_lshlrev_b32 v114, 16, v147
    v_and_b32 v115, 0xffff0000, v147
    v_pk_mul_f32 v[108:109], v[108:109], s[52:53]
    v_pk_mul_f32 v[110:111], v[110:111], s[52:53]
    v_pk_mul_f32 v[112:113], v[112:113], s[52:53]
    v_pk_mul_f32 v[114:115], v[114:115], s[52:53]
    v_cvt_pk_bf16_f32 v144, v108, v109
    v_cvt_pk_bf16_f32 v145, v110, v111
    v_cvt_pk_bf16_f32 v146, v112, v113
    v_cvt_pk_bf16_f32 v147, v114, v115
    v_dot2_f32_bf16 v98, v144, v144, 0
    v_dot2_f32_bf16 v98, v145, v145, v98
    v_dot2_f32_bf16 v98, v146, v146, v98
    v_dot2_f32_bf16 v98, v147, v147, v98
    v_mfma_f32_16x16x32_bf16 v[80:83], v[144:147], v[12:15], 0
    v_lshlrev_b32 v108, 16, v148
    v_and_b32 v109, 0xffff0000, v148
    v_lshlrev_b32 v110, 16, v149
    v_and_b32 v111, 0xffff0000, v149
    v_lshlrev_b32 v112, 16, v150
    v_and_b32 v113, 0xffff0000, v150
    v_lshlrev_b32 v114, 16, v151
    v_and_b32 v115, 0xffff0000, v151
    v_pk_mul_f32 v[108:109], v[108:109], s[52:53]
    v_pk_mul_f32 v[110:111], v[110:111], s[52:53]
    v_pk_mul_f32 v[112:113], v[112:113], s[52:53]
    v_pk_mul_f32 v[114:115], v[114:115], s[52:53]
    v_cvt_pk_bf16_f32 v148, v108, v109
    v_cvt_pk_bf16_f32 v149, v110, v111
    v_cvt_pk_bf16_f32 v150, v112, v113
    v_cvt_pk_bf16_f32 v151, v114, v115
    v_dot2_f32_bf16 v98, v148, v148, v98
    v_dot2_f32_bf16 v98, v149, v149, v98
    v_dot2_f32_bf16 v98, v150, v150, v98
    v_dot2_f32_bf16 v98, v151, v151, v98
    v_mfma_f32_16x16x32_bf16 v[80:83], v[148:151], v[16:19], v[80:83]
    v_lshlrev_b32 v108, 16, v152
    v_and_b32 v109, 0xffff0000, v152
    v_lshlrev_b32 v110, 16, v153
    v_and_b32 v111, 0xffff0000, v153
    v_lshlrev_b32 v112, 16, v154
    v_and_b32 v113, 0xffff0000, v154
    v_lshlrev_b32 v114, 16, v155
    v_and_b32 v115, 0xffff0000, v155
    v_pk_mul_f32 v[108:109], v[108:109], s[52:53]
    v_pk_mul_f32 v[110:111], v[110:111], s[52:53]
    v_pk_mul_f32 v[112:113], v[112:113], s[52:53]
    v_pk_mul_f32 v[114:115], v[114:115], s[52:53]
    v_cvt_pk_bf16_f32 v152, v108, v109
    v_cvt_pk_bf16_f32 v153, v110, v111
    v_cvt_pk_bf16_f32 v154, v112, v113
    v_cvt_pk_bf16_f32 v155, v114, v115
    v_dot2_f32_bf16 v99, v152, v152, 0
    v_dot2_f32_bf16 v99, v153, v153, v99
    v_dot2_f32_bf16 v99, v154, v154, v99
    v_dot2_f32_bf16 v99, v155, v155, v99
    v_mfma_f32_16x16x32_bf16 v[84:87], v[152:155], v[12:15], 0
    v_lshlrev_b32 v108, 16, v156
    v_and_b32 v109, 0xffff0000, v156
    v_lshlrev_b32 v110, 16, v157
    v_and_b32 v111, 0xffff0000, v157
    v_lshlrev_b32 v112, 16, v158
    v_and_b32 v113, 0xffff0000, v158
    v_lshlrev_b32 v114, 16, v159
    v_and_b32 v115, 0xffff0000, v159
    v_pk_mul_f32 v[108:109], v[108:109], s[52:53]
    v_pk_mul_f32 v[110:111], v[110:111], s[52:53]
    v_pk_mul_f32 v[112:113], v[112:113], s[52:53]
    v_pk_mul_f32 v[114:115], v[114:115], s[52:53]
    v_cvt_pk_bf16_f32 v156, v108, v109
    v_cvt_pk_bf16_f32 v157, v110, v111
    v_cvt_pk_bf16_f32 v158, v112, v113
    v_cvt_pk_bf16_f32 v159, v114, v115
    v_dot2_f32_bf16 v99, v156, v156, v99
    v_dot2_f32_bf16 v99, v157, v157, v99
    v_dot2_f32_bf16 v99, v158, v158, v99
    v_dot2_f32_bf16 v99, v159, v159, v99
    v_mfma_f32_16x16x32_bf16 v[84:87], v[156:159], v[16:19], v[84:87]
    v_add_f32_dpp v98, v98, v98 row_ror:8 row_mask:0xf bank_mask:0xf
    s_nop 0
    v_add_f32_dpp v99, v99, v99 row_ror:8 row_mask:0xf bank_mask:0xf
    s_nop 1
    v_mov_b32_dpp v98, v99 quad_perm:[0,1,2,3] row_mask:0xf bank_mask:0xc
    s_nop 1
    v_mfma_f32_16x16x4_f32 v[92:95], v98, v5, 0
    v_permlane32_swap_b32 v72, v76
    v_permlane32_swap_b32 v73, v77
    v_permlane32_swap_b32 v74, v78
    v_permlane32_swap_b32 v75, v79
    v_add_f32_dpp v72, v76, v72 row_ror:8 row_mask:0xf bank_mask:0xf
    v_add_f32_dpp v73, v77, v73 row_ror:8 row_mask:0xf bank_mask:0xf
    v_add_f32_dpp v74, v78, v74 row_ror:8 row_mask:0xf bank_mask:0xf
    v_add_f32_dpp v75, v79, v75 row_ror:8 row_mask:0xf bank_mask:0xf
    v_cvt_pk_bf16_f32 v116, v72, v73
    v_cvt_pk_bf16_f32 v117, v74, v75
    v_lshlrev_b32 v72, 16, v116
    v_and_b32 v73, 0xffff0000, v116
    v_lshlrev_b32 v74, 16, v117
    v_and_b32 v75, 0xffff0000, v117
    v_cvt_pk_bf16_f32 v118, v88, v89
    v_cvt_pk_bf16_f32 v119, v90, v91
    v_lshlrev_b32 v88, 16, v118
    v_and_b32 v89, 0xffff0000, v118
    v_lshlrev_b32 v90, 16, v119
    v_and_b32 v91, 0xffff0000, v119
    v_fma_f32 v72, v88, -0.5, v72
    v_fma_f32 v73, v89, -0.5, v73
    v_fma_f32 v74, v90, -0.5, v74
    v_fma_f32 v75, v91, -0.5, v75
    v_cvt_pk_bf16_f32 v116, v72, v73
    v_cvt_pk_bf16_f32 v117, v74, v75
    v_lshlrev_b32 v72, 16, v116
    v_and_b32 v73, 0xffff0000, v116
    v_lshlrev_b32 v74, 16, v117
    v_and_b32 v75, 0xffff0000, v117
    v_med3_f32 v72, v72, v6, s61
    v_med3_f32 v73, v73, v6, s61
    v_med3_f32 v74, v74, v6, s61
    v_med3_f32 v75, v75, v6, s61
    v_mul_f32 v88, s56, v72
    v_mul_f32 v89, s56, v73
    v_mul_f32 v90, s56, v74
    v_mul_f32 v91, s56, v75
    v_rndne_f32 v116, v88
    v_rndne_f32 v117, v89
    v_rndne_f32 v118, v90
    v_rndne_f32 v119, v91
    v_sub_f32 v88, v88, v116
    v_sub_f32 v89, v89, v117
    v_sub_f32 v90, v90, v118
    v_sub_f32 v91, v91, v119
    v_fma_f32 v88, v72, s57, v88
    v_fma_f32 v89, v73, s57, v89
    v_fma_f32 v90, v74, s57, v90
    v_fma_f32 v91, v75, s57, v91
    v_cvt_i32_f32 v116, v116
    v_cvt_i32_f32 v117, v117
    v_cvt_i32_f32 v118, v118
    v_cvt_i32_f32 v119, v119
    v_exp_f32 v88, v88
    v_exp_f32 v89, v89
    v_exp_f32 v90, v90
    v_exp_f32 v91, v91
    v_ldexp_f32 v72, v88, v116
    v_ldexp_f32 v73, v89, v117
    v_ldexp_f32 v74, v90, v118
    v_ldexp_f32 v75, v91, v119
    v_cvt_pk_bf16_f32 v116, v72, v73
    v_cvt_pk_bf16_f32 v117, v74, v75
    v_lshlrev_b32 v72, 16, v116
    v_and_b32 v73, 0xffff0000, v116
    v_lshlrev_b32 v74, 16, v117
    v_and_b32 v75, 0xffff0000, v117
    v_mul_f32 v72, s58, v72
    v_mul_f32 v73, s58, v73
    v_mul_f32 v74, s58, v74
    v_mul_f32 v75, s58, v75
    v_cvt_pk_bf16_f32 v116, v72, v73
    v_cvt_pk_bf16_f32 v117, v74, v75
    v_lshlrev_b32 v72, 16, v116
    v_and_b32 v73, 0xffff0000, v116
    v_lshlrev_b32 v74, 16, v117
    v_and_b32 v75, 0xffff0000, v117
    v_add_f32 v72, s59, v72
    v_add_f32 v73, s59, v73
    v_add_f32 v74, s59, v74
    v_add_f32 v75, s59, v75
    v_cvt_pk_bf16_f32 v56, v72, v73
    v_cvt_pk_bf16_f32 v57, v74, v75
    v_permlane32_swap_b32 v80, v84
    v_permlane32_swap_b32 v81, v85
    v_permlane32_swap_b32 v82, v86
    v_permlane32_swap_b32 v83, v87
    v_add_f32_dpp v80, v84, v80 row_ror:8 row_mask:0xf bank_mask:0xf
    v_add_f32_dpp v81, v85, v81 row_ror:8 row_mask:0xf bank_mask:0xf
    v_add_f32_dpp v82, v86, v82 row_ror:8 row_mask:0xf bank_mask:0xf
    v_add_f32_dpp v83, v87, v83 row_ror:8 row_mask:0xf bank_mask:0xf
    v_cvt_pk_bf16_f32 v116, v80, v81
    v_cvt_pk_bf16_f32 v117, v82, v83
    v_lshlrev_b32 v80, 16, v116
    v_and_b32 v81, 0xffff0000, v116
    v_lshlrev_b32 v82, 16, v117
    v_and_b32 v83, 0xffff0000, v117
    v_cvt_pk_bf16_f32 v118, v92, v93
    v_cvt_pk_bf16_f32 v119, v94, v95
    v_lshlrev_b32 v92, 16, v118
    v_and_b32 v93, 0xffff0000, v118
    v_lshlrev_b32 v94, 16, v119
    v_and_b32 v95, 0xffff0000, v119
    v_fma_f32 v80, v92, -0.5, v80
    v_fma_f32 v81, v93, -0.5, v81
    v_fma_f32 v82, v94, -0.5, v82
    v_fma_f32 v83, v95, -0.5, v83
    v_cvt_pk_bf16_f32 v116, v80, v81
    v_cvt_pk_bf16_f32 v117, v82, v83
    v_lshlrev_b32 v80, 16, v116
    v_and_b32 v81, 0xffff0000, v116
    v_lshlrev_b32 v82, 16, v117
    v_and_b32 v83, 0xffff0000, v117
    v_med3_f32 v80, v80, v6, s61
    v_med3_f32 v81, v81, v6, s61
    v_med3_f32 v82, v82, v6, s61
    v_med3_f32 v83, v83, v6, s61
    v_mul_f32 v92, s56, v80
    v_mul_f32 v93, s56, v81
    v_mul_f32 v94, s56, v82
    v_mul_f32 v95, s56, v83
    v_rndne_f32 v116, v92
    v_rndne_f32 v117, v93
    v_rndne_f32 v118, v94
    v_rndne_f32 v119, v95
    v_sub_f32 v92, v92, v116
    v_sub_f32 v93, v93, v117
    v_sub_f32 v94, v94, v118
    v_sub_f32 v95, v95, v119
    v_fma_f32 v92, v80, s57, v92
    v_fma_f32 v93, v81, s57, v93
    v_fma_f32 v94, v82, s57, v94
    v_fma_f32 v95, v83, s57, v95
    v_cvt_i32_f32 v116, v116
    v_cvt_i32_f32 v117, v117
    v_cvt_i32_f32 v118, v118
    v_cvt_i32_f32 v119, v119
    v_exp_f32 v92, v92
    v_exp_f32 v93, v93
    v_exp_f32 v94, v94
    v_exp_f32 v95, v95
    v_ldexp_f32 v80, v92, v116
    v_ldexp_f32 v81, v93, v117
    v_ldexp_f32 v82, v94, v118
    v_ldexp_f32 v83, v95, v119
    v_cvt_pk_bf16_f32 v116, v80, v81
    v_cvt_pk_bf16_f32 v117, v82, v83
    v_lshlrev_b32 v80, 16, v116
    v_and_b32 v81, 0xffff0000, v116
    v_lshlrev_b32 v82, 16, v117
    v_and_b32 v83, 0xffff0000, v117
    v_mul_f32 v80, s58, v80
    v_mul_f32 v81, s58, v81
    v_mul_f32 v82, s58, v82
    v_mul_f32 v83, s58, v83
    v_cvt_pk_bf16_f32 v116, v80, v81
    v_cvt_pk_bf16_f32 v117, v82, v83
    v_lshlrev_b32 v80, 16, v116
    v_and_b32 v81, 0xffff0000, v116
    v_lshlrev_b32 v82, 16, v117
    v_and_b32 v83, 0xffff0000, v117
    v_add_f32 v80, s59, v80
    v_add_f32 v81, s59, v81
    v_add_f32 v82, s59, v82
    v_add_f32 v83, s59, v83
    v_cvt_pk_bf16_f32 v58, v80, v81
    v_cvt_pk_bf16_f32 v59, v82, v83
    s_waitcnt vmcnt(12)
    v_lshlrev_b32 v100, 16, v160
    v_and_b32 v101, 0xffff0000, v160
    v_lshlrev_b32 v102, 16, v161
    v_and_b32 v103, 0xffff0000, v161
    v_lshlrev_b32 v104, 16, v162
    v_and_b32 v105, 0xffff0000, v162
    v_lshlrev_b32 v106, 16, v163
    v_and_b32 v107, 0xffff0000, v163
    v_pk_mul_f32 v[100:101], v[100:101], s[52:53]
    v_pk_mul_f32 v[102:103], v[102:103], s[52:53]
    v_pk_mul_f32 v[104:105], v[104:105], s[52:53]
    v_pk_mul_f32 v[106:107], v[106:107], s[52:53]
    v_cvt_pk_bf16_f32 v160, v100, v101
    v_cvt_pk_bf16_f32 v161, v102, v103
    v_cvt_pk_bf16_f32 v162, v104, v105
    v_cvt_pk_bf16_f32 v163, v106, v107
    v_dot2_f32_bf16 v96, v160, v160, 0
    v_dot2_f32_bf16 v96, v161, v161, v96
    v_dot2_f32_bf16 v96, v162, v162, v96
    v_dot2_f32_bf16 v96, v163, v163, v96
    v_mfma_f32_16x16x32_bf16 v[72:75], v[160:163], v[12:15], 0
    v_lshlrev_b32 v100, 16, v164
    v_and_b32 v101, 0xffff0000, v164
    v_lshlrev_b32 v102, 16, v165
    v_and_b32 v103, 0xffff0000, v165
    v_lshlrev_b32 v104, 16, v166
    v_and_b32 v105, 0xffff0000, v166
    v_lshlrev_b32 v106, 16, v167
    v_and_b32 v107, 0xffff0000, v167
    v_pk_mul_f32 v[100:101], v[100:101], s[52:53]
    v_pk_mul_f32 v[102:103], v[102:103], s[52:53]
    v_pk_mul_f32 v[104:105], v[104:105], s[52:53]
    v_pk_mul_f32 v[106:107], v[106:107], s[52:53]
    v_cvt_pk_bf16_f32 v164, v100, v101
    v_cvt_pk_bf16_f32 v165, v102, v103
    v_cvt_pk_bf16_f32 v166, v104, v105
    v_cvt_pk_bf16_f32 v167, v106, v107
    v_dot2_f32_bf16 v96, v164, v164, v96
    v_dot2_f32_bf16 v96, v165, v165, v96
    v_dot2_f32_bf16 v96, v166, v166, v96
    v_dot2_f32_bf16 v96, v167, v167, v96
    v_mfma_f32_16x16x32_bf16 v[72:75], v[164:167], v[16:19], v[72:75]
    v_lshlrev_b32 v100, 16, v168
    v_and_b32 v101, 0xffff0000, v168
    v_lshlrev_b32 v102, 16, v169
    v_and_b32 v103, 0xffff0000, v169
    v_lshlrev_b32 v104, 16, v170
    v_and_b32 v105, 0xffff0000, v170
    v_lshlrev_b32 v106, 16, v171
    v_and_b32 v107, 0xffff0000, v171
    v_pk_mul_f32 v[100:101], v[100:101], s[52:53]
    v_pk_mul_f32 v[102:103], v[102:103], s[52:53]
    v_pk_mul_f32 v[104:105], v[104:105], s[52:53]
    v_pk_mul_f32 v[106:107], v[106:107], s[52:53]
    v_cvt_pk_bf16_f32 v168, v100, v101
    v_cvt_pk_bf16_f32 v169, v102, v103
    v_cvt_pk_bf16_f32 v170, v104, v105
    v_cvt_pk_bf16_f32 v171, v106, v107
    v_dot2_f32_bf16 v97, v168, v168, 0
    v_dot2_f32_bf16 v97, v169, v169, v97
    v_dot2_f32_bf16 v97, v170, v170, v97
    v_dot2_f32_bf16 v97, v171, v171, v97
    v_mfma_f32_16x16x32_bf16 v[76:79], v[168:171], v[12:15], 0
    v_lshlrev_b32 v100, 16, v172
    v_and_b32 v101, 0xffff0000, v172
    v_lshlrev_b32 v102, 16, v173
    v_and_b32 v103, 0xffff0000, v173
    v_lshlrev_b32 v104, 16, v174
    v_and_b32 v105, 0xffff0000, v174
    v_lshlrev_b32 v106, 16, v175
    v_and_b32 v107, 0xffff0000, v175
    v_pk_mul_f32 v[100:101], v[100:101], s[52:53]
    v_pk_mul_f32 v[102:103], v[102:103], s[52:53]
    v_pk_mul_f32 v[104:105], v[104:105], s[52:53]
    v_pk_mul_f32 v[106:107], v[106:107], s[52:53]
    v_cvt_pk_bf16_f32 v172, v100, v101
    v_cvt_pk_bf16_f32 v173, v102, v103
    v_cvt_pk_bf16_f32 v174, v104, v105
    v_cvt_pk_bf16_f32 v175, v106, v107
    v_dot2_f32_bf16 v97, v172, v172, v97
    v_dot2_f32_bf16 v97, v173, v173, v97
    v_dot2_f32_bf16 v97, v174, v174, v97
    v_dot2_f32_bf16 v97, v175, v175, v97
    v_mfma_f32_16x16x32_bf16 v[76:79], v[172:175], v[16:19], v[76:79]
    v_add_f32_dpp v96, v96, v96 row_ror:8 row_mask:0xf bank_mask:0xf
    s_nop 0
    v_add_f32_dpp v97, v97, v97 row_ror:8 row_mask:0xf bank_mask:0xf
    s_nop 1
    v_mov_b32_dpp v96, v97 quad_perm:[0,1,2,3] row_mask:0xf bank_mask:0xc
    s_nop 1
    v_mfma_f32_16x16x4_f32 v[88:91], v96, v5, 0
    s_waitcnt vmcnt(8)
    buffer_load_dwordx4 v[128:131], v2, s[20:23], s66 offen offset:0 nt
    buffer_load_dwordx4 v[132:135], v2, s[20:23], s66 offen offset:128 nt
    buffer_load_dwordx4 v[136:139], v2, s[20:23], s66 offen offset:512 nt
    buffer_load_dwordx4 v[140:143], v2, s[20:23], s66 offen offset:640 nt
    buffer_load_dwordx4 v[144:147], v2, s[20:23], s66 offen offset:1024 nt
    buffer_load_dwordx4 v[148:151], v2, s[20:23], s66 offen offset:1152 nt
    buffer_load_dwordx4 v[152:155], v2, s[20:23], s66 offen offset:1536 nt
    buffer_load_dwordx4 v[156:159], v2, s[20:23], s66 offen offset:1664 nt
    v_lshlrev_b32 v108, 16, v176
    v_and_b32 v109, 0xffff0000, v176
    v_lshlrev_b32 v110, 16, v177
    v_and_b32 v111, 0xffff0000, v177
    v_lshlrev_b32 v112, 16, v178
    v_and_b32 v113, 0xffff0000, v178
    v_lshlrev_b32 v114, 16, v179
    v_and_b32 v115, 0xffff0000, v179
    v_pk_mul_f32 v[108:109], v[108:109], s[52:53]
    v_pk_mul_f32 v[110:111], v[110:111], s[52:53]
    v_pk_mul_f32 v[112:113], v[112:113], s[52:53]
    v_pk_mul_f32 v[114:115], v[114:115], s[52:53]
    v_cvt_pk_bf16_f32 v176, v108, v109
    v_cvt_pk_bf16_f32 v177, v110, v111
    v_cvt_pk_bf16_f32 v178, v112, v113
    v_cvt_pk_bf16_f32 v179, v114, v115
    v_dot2_f32_bf16 v98, v176, v176, 0
    v_dot2_f32_bf16 v98, v177, v177, v98
    v_dot2_f32_bf16 v98, v178, v178, v98
    v_dot2_f32_bf16 v98, v179, v179, v98
    v_mfma_f32_16x16x32_bf16 v[80:83], v[176:179], v[12:15], 0
    v_lshlrev_b32 v108, 16, v180
    v_and_b32 v109, 0xffff0000, v180
    v_lshlrev_b32 v110, 16, v181
    v_and_b32 v111, 0xffff0000, v181
    v_lshlrev_b32 v112, 16, v182
    v_and_b32 v113, 0xffff0000, v182
    v_lshlrev_b32 v114, 16, v183
    v_and_b32 v115, 0xffff0000, v183
    v_pk_mul_f32 v[108:109], v[108:109], s[52:53]
    v_pk_mul_f32 v[110:111], v[110:111], s[52:53]
    v_pk_mul_f32 v[112:113], v[112:113], s[52:53]
    v_pk_mul_f32 v[114:115], v[114:115], s[52:53]
    v_cvt_pk_bf16_f32 v180, v108, v109
    v_cvt_pk_bf16_f32 v181, v110, v111
    v_cvt_pk_bf16_f32 v182, v112, v113
    v_cvt_pk_bf16_f32 v183, v114, v115
    v_dot2_f32_bf16 v98, v180, v180, v98
    v_dot2_f32_bf16 v98, v181, v181, v98
    v_dot2_f32_bf16 v98, v182, v182, v98
    v_dot2_f32_bf16 v98, v183, v183, v98
    v_mfma_f32_16x16x32_bf16 v[80:83], v[180:183], v[16:19], v[80:83]
    v_lshlrev_b32 v108, 16, v184
    v_and_b32 v109, 0xffff0000, v184
    v_lshlrev_b32 v110, 16, v185
    v_and_b32 v111, 0xffff0000, v185
    v_lshlrev_b32 v112, 16, v186
    v_and_b32 v113, 0xffff0000, v186
    v_lshlrev_b32 v114, 16, v187
    v_and_b32 v115, 0xffff0000, v187
    v_pk_mul_f32 v[108:109], v[108:109], s[52:53]
    v_pk_mul_f32 v[110:111], v[110:111], s[52:53]
    v_pk_mul_f32 v[112:113], v[112:113], s[52:53]
    v_pk_mul_f32 v[114:115], v[114:115], s[52:53]
    v_cvt_pk_bf16_f32 v184, v108, v109
    v_cvt_pk_bf16_f32 v185, v110, v111
    v_cvt_pk_bf16_f32 v186, v112, v113
    v_cvt_pk_bf16_f32 v187, v114, v115
    v_dot2_f32_bf16 v99, v184, v184, 0
    v_dot2_f32_bf16 v99, v185, v185, v99
    v_dot2_f32_bf16 v99, v186, v186, v99
    v_dot2_f32_bf16 v99, v187, v187, v99
    v_mfma_f32_16x16x32_bf16 v[84:87], v[184:187], v[12:15], 0
    v_lshlrev_b32 v108, 16, v188
    v_and_b32 v109, 0xffff0000, v188
    v_lshlrev_b32 v110, 16, v189
    v_and_b32 v111, 0xffff0000, v189
    v_lshlrev_b32 v112, 16, v190
    v_and_b32 v113, 0xffff0000, v190
    v_lshlrev_b32 v114, 16, v191
    v_and_b32 v115, 0xffff0000, v191
    v_pk_mul_f32 v[108:109], v[108:109], s[52:53]
    v_pk_mul_f32 v[110:111], v[110:111], s[52:53]
    v_pk_mul_f32 v[112:113], v[112:113], s[52:53]
    v_pk_mul_f32 v[114:115], v[114:115], s[52:53]
    v_cvt_pk_bf16_f32 v188, v108, v109
    v_cvt_pk_bf16_f32 v189, v110, v111
    v_cvt_pk_bf16_f32 v190, v112, v113
    v_cvt_pk_bf16_f32 v191, v114, v115
    v_dot2_f32_bf16 v99, v188, v188, v99
    v_dot2_f32_bf16 v99, v189, v189, v99
    v_dot2_f32_bf16 v99, v190, v190, v99
    v_dot2_f32_bf16 v99, v191, v191, v99
    v_mfma_f32_16x16x32_bf16 v[84:87], v[188:191], v[16:19], v[84:87]
    v_add_f32_dpp v98, v98, v98 row_ror:8 row_mask:0xf bank_mask:0xf
    s_nop 0
    v_add_f32_dpp v99, v99, v99 row_ror:8 row_mask:0xf bank_mask:0xf
    s_nop 1
    v_mov_b32_dpp v98, v99 quad_perm:[0,1,2,3] row_mask:0xf bank_mask:0xc
    s_nop 1
    v_mfma_f32_16x16x4_f32 v[92:95], v98, v5, 0
    v_permlane32_swap_b32 v72, v76
    v_permlane32_swap_b32 v73, v77
    v_permlane32_swap_b32 v74, v78
    v_permlane32_swap_b32 v75, v79
    v_add_f32_dpp v72, v76, v72 row_ror:8 row_mask:0xf bank_mask:0xf
    v_add_f32_dpp v73, v77, v73 row_ror:8 row_mask:0xf bank_mask:0xf
    v_add_f32_dpp v74, v78, v74 row_ror:8 row_mask:0xf bank_mask:0xf
    v_add_f32_dpp v75, v79, v75 row_ror:8 row_mask:0xf bank_mask:0xf
    v_cvt_pk_bf16_f32 v116, v72, v73
    v_cvt_pk_bf16_f32 v117, v74, v75
    v_lshlrev_b32 v72, 16, v116
    v_and_b32 v73, 0xffff0000, v116
    v_lshlrev_b32 v74, 16, v117
    v_and_b32 v75, 0xffff0000, v117
    v_cvt_pk_bf16_f32 v118, v88, v89
    v_cvt_pk_bf16_f32 v119, v90, v91
    v_lshlrev_b32 v88, 16, v118
    v_and_b32 v89, 0xffff0000, v118
    v_lshlrev_b32 v90, 16, v119
    v_and_b32 v91, 0xffff0000, v119
    v_fma_f32 v72, v88, -0.5, v72
    v_fma_f32 v73, v89, -0.5, v73
    v_fma_f32 v74, v90, -0.5, v74
    v_fma_f32 v75, v91, -0.5, v75
    v_cvt_pk_bf16_f32 v116, v72, v73
    v_cvt_pk_bf16_f32 v117, v74, v75
    v_lshlrev_b32 v72, 16, v116
    v_and_b32 v73, 0xffff0000, v116
    v_lshlrev_b32 v74, 16, v117
    v_and_b32 v75, 0xffff0000, v117
    v_med3_f32 v72, v72, v6, s61
    v_med3_f32 v73, v73, v6, s61
    v_med3_f32 v74, v74, v6, s61
    v_med3_f32 v75, v75, v6, s61
    v_mul_f32 v88, s56, v72
    v_mul_f32 v89, s56, v73
    v_mul_f32 v90, s56, v74
    v_mul_f32 v91, s56, v75
    v_rndne_f32 v116, v88
    v_rndne_f32 v117, v89
    v_rndne_f32 v118, v90
    v_rndne_f32 v119, v91
    v_sub_f32 v88, v88, v116
    v_sub_f32 v89, v89, v117
    v_sub_f32 v90, v90, v118
    v_sub_f32 v91, v91, v119
    v_fma_f32 v88, v72, s57, v88
    v_fma_f32 v89, v73, s57, v89
    v_fma_f32 v90, v74, s57, v90
    v_fma_f32 v91, v75, s57, v91
    v_cvt_i32_f32 v116, v116
    v_cvt_i32_f32 v117, v117
    v_cvt_i32_f32 v118, v118
    v_cvt_i32_f32 v119, v119
    v_exp_f32 v88, v88
    v_exp_f32 v89, v89
    v_exp_f32 v90, v90
    v_exp_f32 v91, v91
    v_ldexp_f32 v72, v88, v116
    v_ldexp_f32 v73, v89, v117
    v_ldexp_f32 v74, v90, v118
    v_ldexp_f32 v75, v91, v119
    v_cvt_pk_bf16_f32 v116, v72, v73
    v_cvt_pk_bf16_f32 v117, v74, v75
    v_lshlrev_b32 v72, 16, v116
    v_and_b32 v73, 0xffff0000, v116
    v_lshlrev_b32 v74, 16, v117
    v_and_b32 v75, 0xffff0000, v117
    v_mul_f32 v72, s58, v72
    v_mul_f32 v73, s58, v73
    v_mul_f32 v74, s58, v74
    v_mul_f32 v75, s58, v75
    v_cvt_pk_bf16_f32 v116, v72, v73
    v_cvt_pk_bf16_f32 v117, v74, v75
    v_lshlrev_b32 v72, 16, v116
    v_and_b32 v73, 0xffff0000, v116
    v_lshlrev_b32 v74, 16, v117
    v_and_b32 v75, 0xffff0000, v117
    v_add_f32 v72, s59, v72
    v_add_f32 v73, s59, v73
    v_add_f32 v74, s59, v74
    v_add_f32 v75, s59, v75
    v_cvt_pk_bf16_f32 v60, v72, v73
    v_cvt_pk_bf16_f32 v61, v74, v75
    v_permlane32_swap_b32 v80, v84
    v_permlane32_swap_b32 v81, v85
    v_permlane32_swap_b32 v82, v86
    v_permlane32_swap_b32 v83, v87
    v_add_f32_dpp v80, v84, v80 row_ror:8 row_mask:0xf bank_mask:0xf
    v_add_f32_dpp v81, v85, v81 row_ror:8 row_mask:0xf bank_mask:0xf
    v_add_f32_dpp v82, v86, v82 row_ror:8 row_mask:0xf bank_mask:0xf
    v_add_f32_dpp v83, v87, v83 row_ror:8 row_mask:0xf bank_mask:0xf
    v_cvt_pk_bf16_f32 v116, v80, v81
    v_cvt_pk_bf16_f32 v117, v82, v83
    v_lshlrev_b32 v80, 16, v116
    v_and_b32 v81, 0xffff0000, v116
    v_lshlrev_b32 v82, 16, v117
    v_and_b32 v83, 0xffff0000, v117
    v_cvt_pk_bf16_f32 v118, v92, v93
    v_cvt_pk_bf16_f32 v119, v94, v95
    v_lshlrev_b32 v92, 16, v118
    v_and_b32 v93, 0xffff0000, v118
    v_lshlrev_b32 v94, 16, v119
    v_and_b32 v95, 0xffff0000, v119
    v_fma_f32 v80, v92, -0.5, v80
    v_fma_f32 v81, v93, -0.5, v81
    v_fma_f32 v82, v94, -0.5, v82
    v_fma_f32 v83, v95, -0.5, v83
    v_cvt_pk_bf16_f32 v116, v80, v81
    v_cvt_pk_bf16_f32 v117, v82, v83
    v_lshlrev_b32 v80, 16, v116
    v_and_b32 v81, 0xffff0000, v116
    v_lshlrev_b32 v82, 16, v117
    v_and_b32 v83, 0xffff0000, v117
    v_med3_f32 v80, v80, v6, s61
    v_med3_f32 v81, v81, v6, s61
    v_med3_f32 v82, v82, v6, s61
    v_med3_f32 v83, v83, v6, s61
    v_mul_f32 v92, s56, v80
    v_mul_f32 v93, s56, v81
    v_mul_f32 v94, s56, v82
    v_mul_f32 v95, s56, v83
    v_rndne_f32 v116, v92
    v_rndne_f32 v117, v93
    v_rndne_f32 v118, v94
    v_rndne_f32 v119, v95
    v_sub_f32 v92, v92, v116
    v_sub_f32 v93, v93, v117
    v_sub_f32 v94, v94, v118
    v_sub_f32 v95, v95, v119
    v_fma_f32 v92, v80, s57, v92
    v_fma_f32 v93, v81, s57, v93
    v_fma_f32 v94, v82, s57, v94
    v_fma_f32 v95, v83, s57, v95
    v_cvt_i32_f32 v116, v116
    v_cvt_i32_f32 v117, v117
    v_cvt_i32_f32 v118, v118
    v_cvt_i32_f32 v119, v119
    v_exp_f32 v92, v92
    v_exp_f32 v93, v93
    v_exp_f32 v94, v94
    v_exp_f32 v95, v95
    v_ldexp_f32 v80, v92, v116
    v_ldexp_f32 v81, v93, v117
    v_ldexp_f32 v82, v94, v118
    v_ldexp_f32 v83, v95, v119
    v_cvt_pk_bf16_f32 v116, v80, v81
    v_cvt_pk_bf16_f32 v117, v82, v83
    v_lshlrev_b32 v80, 16, v116
    v_and_b32 v81, 0xffff0000, v116
    v_lshlrev_b32 v82, 16, v117
    v_and_b32 v83, 0xffff0000, v117
    v_mul_f32 v80, s58, v80
    v_mul_f32 v81, s58, v81
    v_mul_f32 v82, s58, v82
    v_mul_f32 v83, s58, v83
    v_cvt_pk_bf16_f32 v116, v80, v81
    v_cvt_pk_bf16_f32 v117, v82, v83
    v_lshlrev_b32 v80, 16, v116
    v_and_b32 v81, 0xffff0000, v116
    v_lshlrev_b32 v82, 16, v117
    v_and_b32 v83, 0xffff0000, v117
    v_add_f32 v80, s59, v80
    v_add_f32 v81, s59, v81
    v_add_f32 v82, s59, v82
    v_add_f32 v83, s59, v83
    v_cvt_pk_bf16_f32 v62, v80, v81
    v_cvt_pk_bf16_f32 v63, v82, v83
    s_waitcnt vmcnt(8)
    buffer_load_dwordx4 v[160:163], v3, s[24:27], s65 offen offset:0 nt
    buffer_load_dwordx4 v[164:167], v3, s[24:27], s65 offen offset:2048 nt
    buffer_load_dwordx4 v[168:171], v3, s[24:27], s69 offen offset:0 nt
    buffer_load_dwordx4 v[172:175], v3, s[24:27], s69 offen offset:2048 nt
    buffer_load_dwordx4 v[176:179], v3, s[24:27], s65 offen offset:1024 nt
    buffer_load_dwordx4 v[180:183], v3, s[24:27], s65 offen offset:3072 nt
    buffer_load_dwordx4 v[184:187], v3, s[24:27], s69 offen offset:1024 nt
    buffer_load_dwordx4 v[188:191], v3, s[24:27], s69 offen offset:3072 nt
    v_mfma_f32_16x16x32_bf16 v[52:55], v[56:59], v[8:11], v[52:55]
    v_perm_b32 v100, v196, v192, s54
    v_perm_b32 v104, v196, v192, s55
    v_perm_b32 v101, v204, v200, s54
    v_perm_b32 v105, v204, v200, s55
    v_perm_b32 v102, v212, v208, s54
    v_perm_b32 v106, v212, v208, s55
    v_perm_b32 v103, v220, v216, s54
    v_perm_b32 v107, v220, v216, s55
    s_nop 0
    v_mfma_f32_16x16x32_bf16 v[20:23], v[56:59], v[100:103], v[20:23]
    v_mfma_f32_16x16x32_bf16 v[24:27], v[56:59], v[104:107], v[24:27]
    v_perm_b32 v108, v197, v193, s54
    v_perm_b32 v112, v197, v193, s55
    v_perm_b32 v109, v205, v201, s54
    v_perm_b32 v113, v205, v201, s55
    v_perm_b32 v110, v213, v209, s54
    v_perm_b32 v114, v213, v209, s55
    v_perm_b32 v111, v221, v217, s54
    v_perm_b32 v115, v221, v217, s55
    s_nop 0
    v_mfma_f32_16x16x32_bf16 v[28:31], v[56:59], v[108:111], v[28:31]
    v_mfma_f32_16x16x32_bf16 v[32:35], v[56:59], v[112:115], v[32:35]
    v_perm_b32 v100, v198, v194, s54
    v_perm_b32 v104, v198, v194, s55
    v_perm_b32 v101, v206, v202, s54
    v_perm_b32 v105, v206, v202, s55
    v_perm_b32 v102, v214, v210, s54
    v_perm_b32 v106, v214, v210, s55
    v_perm_b32 v103, v222, v218, s54
    v_perm_b32 v107, v222, v218, s55
    s_nop 0
    v_mfma_f32_16x16x32_bf16 v[36:39], v[56:59], v[100:103], v[36:39]
    v_mfma_f32_16x16x32_bf16 v[40:43], v[56:59], v[104:107], v[40:43]
    v_perm_b32 v108, v199, v195, s54
    v_perm_b32 v112, v199, v195, s55
    v_perm_b32 v109, v207, v203, s54
    v_perm_b32 v113, v207, v203, s55
    v_perm_b32 v110, v215, v211, s54
    v_perm_b32 v114, v215, v211, s55
    v_perm_b32 v111, v223, v219, s54
    v_perm_b32 v115, v223, v219, s55
    s_nop 0
    v_mfma_f32_16x16x32_bf16 v[44:47], v[56:59], v[108:111], v[44:47]
    v_mfma_f32_16x16x32_bf16 v[48:51], v[56:59], v[112:115], v[48:51]
    s_waitcnt vmcnt(12)
    v_lshlrev_b32 v100, 16, v128
    v_and_b32 v101, 0xffff0000, v128
    v_lshlrev_b32 v102, 16, v129
    v_and_b32 v103, 0xffff0000, v129
    v_lshlrev_b32 v104, 16, v130
    v_and_b32 v105, 0xffff0000, v130
    v_lshlrev_b32 v106, 16, v131
    v_and_b32 v107, 0xffff0000, v131
    v_pk_mul_f32 v[100:101], v[100:101], s[52:53]
    v_pk_mul_f32 v[102:103], v[102:103], s[52:53]
    v_pk_mul_f32 v[104:105], v[104:105], s[52:53]
    v_pk_mul_f32 v[106:107], v[106:107], s[52:53]
    v_cvt_pk_bf16_f32 v128, v100, v101
    v_cvt_pk_bf16_f32 v129, v102, v103
    v_cvt_pk_bf16_f32 v130, v104, v105
    v_cvt_pk_bf16_f32 v131, v106, v107
    v_dot2_f32_bf16 v96, v128, v128, 0
    v_dot2_f32_bf16 v96, v129, v129, v96
    v_dot2_f32_bf16 v96, v130, v130, v96
    v_dot2_f32_bf16 v96, v131, v131, v96
    v_mfma_f32_16x16x32_bf16 v[72:75], v[128:131], v[12:15], 0
    v_lshlrev_b32 v100, 16, v132
    v_and_b32 v101, 0xffff0000, v132
    v_lshlrev_b32 v102, 16, v133
    v_and_b32 v103, 0xffff0000, v133
    v_lshlrev_b32 v104, 16, v134
    v_and_b32 v105, 0xffff0000, v134
    v_lshlrev_b32 v106, 16, v135
    v_and_b32 v107, 0xffff0000, v135
    v_pk_mul_f32 v[100:101], v[100:101], s[52:53]
    v_pk_mul_f32 v[102:103], v[102:103], s[52:53]
    v_pk_mul_f32 v[104:105], v[104:105], s[52:53]
    v_pk_mul_f32 v[106:107], v[106:107], s[52:53]
    v_cvt_pk_bf16_f32 v132, v100, v101
    v_cvt_pk_bf16_f32 v133, v102, v103
    v_cvt_pk_bf16_f32 v134, v104, v105
    v_cvt_pk_bf16_f32 v135, v106, v107
    v_dot2_f32_bf16 v96, v132, v132, v96
    v_dot2_f32_bf16 v96, v133, v133, v96
    v_dot2_f32_bf16 v96, v134, v134, v96
    v_dot2_f32_bf16 v96, v135, v135, v96
    v_mfma_f32_16x16x32_bf16 v[72:75], v[132:135], v[16:19], v[72:75]
    v_lshlrev_b32 v100, 16, v136
    v_and_b32 v101, 0xffff0000, v136
    v_lshlrev_b32 v102, 16, v137
    v_and_b32 v103, 0xffff0000, v137
    v_lshlrev_b32 v104, 16, v138
    v_and_b32 v105, 0xffff0000, v138
    v_lshlrev_b32 v106, 16, v139
    v_and_b32 v107, 0xffff0000, v139
    v_pk_mul_f32 v[100:101], v[100:101], s[52:53]
    v_pk_mul_f32 v[102:103], v[102:103], s[52:53]
    v_pk_mul_f32 v[104:105], v[104:105], s[52:53]
    v_pk_mul_f32 v[106:107], v[106:107], s[52:53]
    v_cvt_pk_bf16_f32 v136, v100, v101
    v_cvt_pk_bf16_f32 v137, v102, v103
    v_cvt_pk_bf16_f32 v138, v104, v105
    v_cvt_pk_bf16_f32 v139, v106, v107
    v_dot2_f32_bf16 v97, v136, v136, 0
    v_dot2_f32_bf16 v97, v137, v137, v97
    v_dot2_f32_bf16 v97, v138, v138, v97
    v_dot2_f32_bf16 v97, v139, v139, v97
    v_mfma_f32_16x16x32_bf16 v[76:79], v[136:139], v[12:15], 0
    v_lshlrev_b32 v100, 16, v140
    v_and_b32 v101, 0xffff0000, v140
    v_lshlrev_b32 v102, 16, v141
    v_and_b32 v103, 0xffff0000, v141
    v_lshlrev_b32 v104, 16, v142
    v_and_b32 v105, 0xffff0000, v142
    v_lshlrev_b32 v106, 16, v143
    v_and_b32 v107, 0xffff0000, v143
    v_pk_mul_f32 v[100:101], v[100:101], s[52:53]
    v_pk_mul_f32 v[102:103], v[102:103], s[52:53]
    v_pk_mul_f32 v[104:105], v[104:105], s[52:53]
    v_pk_mul_f32 v[106:107], v[106:107], s[52:53]
    v_cvt_pk_bf16_f32 v140, v100, v101
    v_cvt_pk_bf16_f32 v141, v102, v103
    v_cvt_pk_bf16_f32 v142, v104, v105
    v_cvt_pk_bf16_f32 v143, v106, v107
    v_dot2_f32_bf16 v97, v140, v140, v97
    v_dot2_f32_bf16 v97, v141, v141, v97
    v_dot2_f32_bf16 v97, v142, v142, v97
    v_dot2_f32_bf16 v97, v143, v143, v97
    v_mfma_f32_16x16x32_bf16 v[76:79], v[140:143], v[16:19], v[76:79]
    v_add_f32_dpp v96, v96, v96 row_ror:8 row_mask:0xf bank_mask:0xf
    s_nop 0
    v_add_f32_dpp v97, v97, v97 row_ror:8 row_mask:0xf bank_mask:0xf
    s_nop 1
    v_mov_b32_dpp v96, v97 quad_perm:[0,1,2,3] row_mask:0xf bank_mask:0xc
    s_nop 1
    v_mfma_f32_16x16x4_f32 v[88:91], v96, v5, 0
    s_waitcnt vmcnt(8)
    buffer_load_dwordx4 v[192:195], v2, s[20:23], s67 offen offset:0 nt
    buffer_load_dwordx4 v[196:199], v2, s[20:23], s67 offen offset:128 nt
    buffer_load_dwordx4 v[200:203], v2, s[20:23], s67 offen offset:512 nt
    buffer_load_dwordx4 v[204:207], v2, s[20:23], s67 offen offset:640 nt
    buffer_load_dwordx4 v[208:211], v2, s[20:23], s67 offen offset:1024 nt
    buffer_load_dwordx4 v[212:215], v2, s[20:23], s67 offen offset:1152 nt
    buffer_load_dwordx4 v[216:219], v2, s[20:23], s67 offen offset:1536 nt
    buffer_load_dwordx4 v[220:223], v2, s[20:23], s67 offen offset:1664 nt
    v_lshlrev_b32 v108, 16, v144
    v_and_b32 v109, 0xffff0000, v144
    v_lshlrev_b32 v110, 16, v145
    v_and_b32 v111, 0xffff0000, v145
    v_lshlrev_b32 v112, 16, v146
    v_and_b32 v113, 0xffff0000, v146
    v_lshlrev_b32 v114, 16, v147
    v_and_b32 v115, 0xffff0000, v147
    v_pk_mul_f32 v[108:109], v[108:109], s[52:53]
    v_pk_mul_f32 v[110:111], v[110:111], s[52:53]
    v_pk_mul_f32 v[112:113], v[112:113], s[52:53]
    v_pk_mul_f32 v[114:115], v[114:115], s[52:53]
    v_cvt_pk_bf16_f32 v144, v108, v109
    v_cvt_pk_bf16_f32 v145, v110, v111
    v_cvt_pk_bf16_f32 v146, v112, v113
    v_cvt_pk_bf16_f32 v147, v114, v115
    v_dot2_f32_bf16 v98, v144, v144, 0
    v_dot2_f32_bf16 v98, v145, v145, v98
    v_dot2_f32_bf16 v98, v146, v146, v98
    v_dot2_f32_bf16 v98, v147, v147, v98
    v_mfma_f32_16x16x32_bf16 v[80:83], v[144:147], v[12:15], 0
    v_lshlrev_b32 v108, 16, v148
    v_and_b32 v109, 0xffff0000, v148
    v_lshlrev_b32 v110, 16, v149
    v_and_b32 v111, 0xffff0000, v149
    v_lshlrev_b32 v112, 16, v150
    v_and_b32 v113, 0xffff0000, v150
    v_lshlrev_b32 v114, 16, v151
    v_and_b32 v115, 0xffff0000, v151
    v_pk_mul_f32 v[108:109], v[108:109], s[52:53]
    v_pk_mul_f32 v[110:111], v[110:111], s[52:53]
    v_pk_mul_f32 v[112:113], v[112:113], s[52:53]
    v_pk_mul_f32 v[114:115], v[114:115], s[52:53]
    v_cvt_pk_bf16_f32 v148, v108, v109
    v_cvt_pk_bf16_f32 v149, v110, v111
    v_cvt_pk_bf16_f32 v150, v112, v113
    v_cvt_pk_bf16_f32 v151, v114, v115
    v_dot2_f32_bf16 v98, v148, v148, v98
    v_dot2_f32_bf16 v98, v149, v149, v98
    v_dot2_f32_bf16 v98, v150, v150, v98
    v_dot2_f32_bf16 v98, v151, v151, v98
    v_mfma_f32_16x16x32_bf16 v[80:83], v[148:151], v[16:19], v[80:83]
    v_lshlrev_b32 v108, 16, v152
    v_and_b32 v109, 0xffff0000, v152
    v_lshlrev_b32 v110, 16, v153
    v_and_b32 v111, 0xffff0000, v153
    v_lshlrev_b32 v112, 16, v154
    v_and_b32 v113, 0xffff0000, v154
    v_lshlrev_b32 v114, 16, v155
    v_and_b32 v115, 0xffff0000, v155
    v_pk_mul_f32 v[108:109], v[108:109], s[52:53]
    v_pk_mul_f32 v[110:111], v[110:111], s[52:53]
    v_pk_mul_f32 v[112:113], v[112:113], s[52:53]
    v_pk_mul_f32 v[114:115], v[114:115], s[52:53]
    v_cvt_pk_bf16_f32 v152, v108, v109
    v_cvt_pk_bf16_f32 v153, v110, v111
    v_cvt_pk_bf16_f32 v154, v112, v113
    v_cvt_pk_bf16_f32 v155, v114, v115
    v_dot2_f32_bf16 v99, v152, v152, 0
    v_dot2_f32_bf16 v99, v153, v153, v99
    v_dot2_f32_bf16 v99, v154, v154, v99
    v_dot2_f32_bf16 v99, v155, v155, v99
    v_mfma_f32_16x16x32_bf16 v[84:87], v[152:155], v[12:15], 0
    v_lshlrev_b32 v108, 16, v156
    v_and_b32 v109, 0xffff0000, v156
    v_lshlrev_b32 v110, 16, v157
    v_and_b32 v111, 0xffff0000, v157
    v_lshlrev_b32 v112, 16, v158
    v_and_b32 v113, 0xffff0000, v158
    v_lshlrev_b32 v114, 16, v159
    v_and_b32 v115, 0xffff0000, v159
    v_pk_mul_f32 v[108:109], v[108:109], s[52:53]
    v_pk_mul_f32 v[110:111], v[110:111], s[52:53]
    v_pk_mul_f32 v[112:113], v[112:113], s[52:53]
    v_pk_mul_f32 v[114:115], v[114:115], s[52:53]
    v_cvt_pk_bf16_f32 v156, v108, v109
    v_cvt_pk_bf16_f32 v157, v110, v111
    v_cvt_pk_bf16_f32 v158, v112, v113
    v_cvt_pk_bf16_f32 v159, v114, v115
    v_dot2_f32_bf16 v99, v156, v156, v99
    v_dot2_f32_bf16 v99, v157, v157, v99
    v_dot2_f32_bf16 v99, v158, v158, v99
    v_dot2_f32_bf16 v99, v159, v159, v99
    v_mfma_f32_16x16x32_bf16 v[84:87], v[156:159], v[16:19], v[84:87]
    v_add_f32_dpp v98, v98, v98 row_ror:8 row_mask:0xf bank_mask:0xf
    s_nop 0
    v_add_f32_dpp v99, v99, v99 row_ror:8 row_mask:0xf bank_mask:0xf
    s_nop 1
    v_mov_b32_dpp v98, v99 quad_perm:[0,1,2,3] row_mask:0xf bank_mask:0xc
    s_nop 1
    v_mfma_f32_16x16x4_f32 v[92:95], v98, v5, 0
    v_permlane32_swap_b32 v72, v76
    v_permlane32_swap_b32 v73, v77
    v_permlane32_swap_b32 v74, v78
    v_permlane32_swap_b32 v75, v79
    v_add_f32_dpp v72, v76, v72 row_ror:8 row_mask:0xf bank_mask:0xf
    v_add_f32_dpp v73, v77, v73 row_ror:8 row_mask:0xf bank_mask:0xf
    v_add_f32_dpp v74, v78, v74 row_ror:8 row_mask:0xf bank_mask:0xf
    v_add_f32_dpp v75, v79, v75 row_ror:8 row_mask:0xf bank_mask:0xf
    v_cvt_pk_bf16_f32 v116, v72, v73
    v_cvt_pk_bf16_f32 v117, v74, v75
    v_lshlrev_b32 v72, 16, v116
    v_and_b32 v73, 0xffff0000, v116
    v_lshlrev_b32 v74, 16, v117
    v_and_b32 v75, 0xffff0000, v117
    v_cvt_pk_bf16_f32 v118, v88, v89
    v_cvt_pk_bf16_f32 v119, v90, v91
    v_lshlrev_b32 v88, 16, v118
    v_and_b32 v89, 0xffff0000, v118
    v_lshlrev_b32 v90, 16, v119
    v_and_b32 v91, 0xffff0000, v119
    v_fma_f32 v72, v88, -0.5, v72
    v_fma_f32 v73, v89, -0.5, v73
    v_fma_f32 v74, v90, -0.5, v74
    v_fma_f32 v75, v91, -0.5, v75
    v_cvt_pk_bf16_f32 v116, v72, v73
    v_cvt_pk_bf16_f32 v117, v74, v75
    v_lshlrev_b32 v72, 16, v116
    v_and_b32 v73, 0xffff0000, v116
    v_lshlrev_b32 v74, 16, v117
    v_and_b32 v75, 0xffff0000, v117
    v_med3_f32 v72, v72, v6, s61
    v_med3_f32 v73, v73, v6, s61
    v_med3_f32 v74, v74, v6, s61
    v_med3_f32 v75, v75, v6, s61
    v_mul_f32 v88, s56, v72
    v_mul_f32 v89, s56, v73
    v_mul_f32 v90, s56, v74
    v_mul_f32 v91, s56, v75
    v_rndne_f32 v116, v88
    v_rndne_f32 v117, v89
    v_rndne_f32 v118, v90
    v_rndne_f32 v119, v91
    v_sub_f32 v88, v88, v116
    v_sub_f32 v89, v89, v117
    v_sub_f32 v90, v90, v118
    v_sub_f32 v91, v91, v119
    v_fma_f32 v88, v72, s57, v88
    v_fma_f32 v89, v73, s57, v89
    v_fma_f32 v90, v74, s57, v90
    v_fma_f32 v91, v75, s57, v91
    v_cvt_i32_f32 v116, v116
    v_cvt_i32_f32 v117, v117
    v_cvt_i32_f32 v118, v118
    v_cvt_i32_f32 v119, v119
    v_exp_f32 v88, v88
    v_exp_f32 v89, v89
    v_exp_f32 v90, v90
    v_exp_f32 v91, v91
    v_ldexp_f32 v72, v88, v116
    v_ldexp_f32 v73, v89, v117
    v_ldexp_f32 v74, v90, v118
    v_ldexp_f32 v75, v91, v119
    v_cvt_pk_bf16_f32 v116, v72, v73
    v_cvt_pk_bf16_f32 v117, v74, v75
    v_lshlrev_b32 v72, 16, v116
    v_and_b32 v73, 0xffff0000, v116
    v_lshlrev_b32 v74, 16, v117
    v_and_b32 v75, 0xffff0000, v117
    v_mul_f32 v72, s58, v72
    v_mul_f32 v73, s58, v73
    v_mul_f32 v74, s58, v74
    v_mul_f32 v75, s58, v75
    v_cvt_pk_bf16_f32 v116, v72, v73
    v_cvt_pk_bf16_f32 v117, v74, v75
    v_lshlrev_b32 v72, 16, v116
    v_and_b32 v73, 0xffff0000, v116
    v_lshlrev_b32 v74, 16, v117
    v_and_b32 v75, 0xffff0000, v117
    v_add_f32 v72, s59, v72
    v_add_f32 v73, s59, v73
    v_add_f32 v74, s59, v74
    v_add_f32 v75, s59, v75
    v_cvt_pk_bf16_f32 v64, v72, v73
    v_cvt_pk_bf16_f32 v65, v74, v75
    v_permlane32_swap_b32 v80, v84
    v_permlane32_swap_b32 v81, v85
    v_permlane32_swap_b32 v82, v86
    v_permlane32_swap_b32 v83, v87
    v_add_f32_dpp v80, v84, v80 row_ror:8 row_mask:0xf bank_mask:0xf
    v_add_f32_dpp v81, v85, v81 row_ror:8 row_mask:0xf bank_mask:0xf
    v_add_f32_dpp v82, v86, v82 row_ror:8 row_mask:0xf bank_mask:0xf
    v_add_f32_dpp v83, v87, v83 row_ror:8 row_mask:0xf bank_mask:0xf
    v_cvt_pk_bf16_f32 v116, v80, v81
    v_cvt_pk_bf16_f32 v117, v82, v83
    v_lshlrev_b32 v80, 16, v116
    v_and_b32 v81, 0xffff0000, v116
    v_lshlrev_b32 v82, 16, v117
    v_and_b32 v83, 0xffff0000, v117
    v_cvt_pk_bf16_f32 v118, v92, v93
    v_cvt_pk_bf16_f32 v119, v94, v95
    v_lshlrev_b32 v92, 16, v118
    v_and_b32 v93, 0xffff0000, v118
    v_lshlrev_b32 v94, 16, v119
    v_and_b32 v95, 0xffff0000, v119
    v_fma_f32 v80, v92, -0.5, v80
    v_fma_f32 v81, v93, -0.5, v81
    v_fma_f32 v82, v94, -0.5, v82
    v_fma_f32 v83, v95, -0.5, v83
    v_cvt_pk_bf16_f32 v116, v80, v81
    v_cvt_pk_bf16_f32 v117, v82, v83
    v_lshlrev_b32 v80, 16, v116
    v_and_b32 v81, 0xffff0000, v116
    v_lshlrev_b32 v82, 16, v117
    v_and_b32 v83, 0xffff0000, v117
    v_med3_f32 v80, v80, v6, s61
    v_med3_f32 v81, v81, v6, s61
    v_med3_f32 v82, v82, v6, s61
    v_med3_f32 v83, v83, v6, s61
    v_mul_f32 v92, s56, v80
    v_mul_f32 v93, s56, v81
    v_mul_f32 v94, s56, v82
    v_mul_f32 v95, s56, v83
    v_rndne_f32 v116, v92
    v_rndne_f32 v117, v93
    v_rndne_f32 v118, v94
    v_rndne_f32 v119, v95
    v_sub_f32 v92, v92, v116
    v_sub_f32 v93, v93, v117
    v_sub_f32 v94, v94, v118
    v_sub_f32 v95, v95, v119
    v_fma_f32 v92, v80, s57, v92
    v_fma_f32 v93, v81, s57, v93
    v_fma_f32 v94, v82, s57, v94
    v_fma_f32 v95, v83, s57, v95
    v_cvt_i32_f32 v116, v116
    v_cvt_i32_f32 v117, v117
    v_cvt_i32_f32 v118, v118
    v_cvt_i32_f32 v119, v119
    v_exp_f32 v92, v92
    v_exp_f32 v93, v93
    v_exp_f32 v94, v94
    v_exp_f32 v95, v95
    v_ldexp_f32 v80, v92, v116
    v_ldexp_f32 v81, v93, v117
    v_ldexp_f32 v82, v94, v118
    v_ldexp_f32 v83, v95, v119
    v_cvt_pk_bf16_f32 v116, v80, v81
    v_cvt_pk_bf16_f32 v117, v82, v83
    v_lshlrev_b32 v80, 16, v116
    v_and_b32 v81, 0xffff0000, v116
    v_lshlrev_b32 v82, 16, v117
    v_and_b32 v83, 0xffff0000, v117
    v_mul_f32 v80, s58, v80
    v_mul_f32 v81, s58, v81
    v_mul_f32 v82, s58, v82
    v_mul_f32 v83, s58, v83
    v_cvt_pk_bf16_f32 v116, v80, v81
    v_cvt_pk_bf16_f32 v117, v82, v83
    v_lshlrev_b32 v80, 16, v116
    v_and_b32 v81, 0xffff0000, v116
    v_lshlrev_b32 v82, 16, v117
    v_and_b32 v83, 0xffff0000, v117
    v_add_f32 v80, s59, v80
    v_add_f32 v81, s59, v81
    v_add_f32 v82, s59, v82
    v_add_f32 v83, s59, v83
    v_cvt_pk_bf16_f32 v66, v80, v81
    v_cvt_pk_bf16_f32 v67, v82, v83
    s_waitcnt vmcnt(8)
    buffer_load_dwordx4 v[128:131], v3, s[24:27], s66 offen offset:0 nt
    buffer_load_dwordx4 v[132:135], v3, s[24:27], s66 offen offset:2048 nt
    buffer_load_dwordx4 v[136:139], v3, s[24:27], s70 offen offset:0 nt
    buffer_load_dwordx4 v[140:143], v3, s[24:27], s70 offen offset:2048 nt
    buffer_load_dwordx4 v[144:147], v3, s[24:27], s66 offen offset:1024 nt
    buffer_load_dwordx4 v[148:151], v3, s[24:27], s66 offen offset:3072 nt
    buffer_load_dwordx4 v[152:155], v3, s[24:27], s70 offen offset:1024 nt
    buffer_load_dwordx4 v[156:159], v3, s[24:27], s70 offen offset:3072 nt
    v_mfma_f32_16x16x32_bf16 v[52:55], v[60:63], v[8:11], v[52:55]
    v_perm_b32 v100, v164, v160, s54
    v_perm_b32 v104, v164, v160, s55
    v_perm_b32 v101, v172, v168, s54
    v_perm_b32 v105, v172, v168, s55
    v_perm_b32 v102, v180, v176, s54
    v_perm_b32 v106, v180, v176, s55
    v_perm_b32 v103, v188, v184, s54
    v_perm_b32 v107, v188, v184, s55
    s_nop 0
    v_mfma_f32_16x16x32_bf16 v[20:23], v[60:63], v[100:103], v[20:23]
    v_mfma_f32_16x16x32_bf16 v[24:27], v[60:63], v[104:107], v[24:27]
    v_perm_b32 v108, v165, v161, s54
    v_perm_b32 v112, v165, v161, s55
    v_perm_b32 v109, v173, v169, s54
    v_perm_b32 v113, v173, v169, s55
    v_perm_b32 v110, v181, v177, s54
    v_perm_b32 v114, v181, v177, s55
    v_perm_b32 v111, v189, v185, s54
    v_perm_b32 v115, v189, v185, s55
    s_nop 0
    v_mfma_f32_16x16x32_bf16 v[28:31], v[60:63], v[108:111], v[28:31]
    v_mfma_f32_16x16x32_bf16 v[32:35], v[60:63], v[112:115], v[32:35]
    v_perm_b32 v100, v166, v162, s54
    v_perm_b32 v104, v166, v162, s55
    v_perm_b32 v101, v174, v170, s54
    v_perm_b32 v105, v174, v170, s55
    v_perm_b32 v102, v182, v178, s54
    v_perm_b32 v106, v182, v178, s55
    v_perm_b32 v103, v190, v186, s54
    v_perm_b32 v107, v190, v186, s55
    s_nop 0
    v_mfma_f32_16x16x32_bf16 v[36:39], v[60:63], v[100:103], v[36:39]
    v_mfma_f32_16x16x32_bf16 v[40:43], v[60:63], v[104:107], v[40:43]
    v_perm_b32 v108, v167, v163, s54
    v_perm_b32 v112, v167, v163, s55
    v_perm_b32 v109, v175, v171, s54
    v_perm_b32 v113, v175, v171, s55
    v_perm_b32 v110, v183, v179, s54
    v_perm_b32 v114, v183, v179, s55
    v_perm_b32 v111, v191, v187, s54
    v_perm_b32 v115, v191, v187, s55
    s_nop 0
    v_mfma_f32_16x16x32_bf16 v[44:47], v[60:63], v[108:111], v[44:47]
    v_mfma_f32_16x16x32_bf16 v[48:51], v[60:63], v[112:115], v[48:51]
    s_waitcnt vmcnt(12)
    v_lshlrev_b32 v100, 16, v192
    v_and_b32 v101, 0xffff0000, v192
    v_lshlrev_b32 v102, 16, v193
    v_and_b32 v103, 0xffff0000, v193
    v_lshlrev_b32 v104, 16, v194
    v_and_b32 v105, 0xffff0000, v194
    v_lshlrev_b32 v106, 16, v195
    v_and_b32 v107, 0xffff0000, v195
    v_pk_mul_f32 v[100:101], v[100:101], s[52:53]
    v_pk_mul_f32 v[102:103], v[102:103], s[52:53]
    v_pk_mul_f32 v[104:105], v[104:105], s[52:53]
    v_pk_mul_f32 v[106:107], v[106:107], s[52:53]
    v_cvt_pk_bf16_f32 v192, v100, v101
    v_cvt_pk_bf16_f32 v193, v102, v103
    v_cvt_pk_bf16_f32 v194, v104, v105
    v_cvt_pk_bf16_f32 v195, v106, v107
    v_dot2_f32_bf16 v96, v192, v192, 0
    v_dot2_f32_bf16 v96, v193, v193, v96
    v_dot2_f32_bf16 v96, v194, v194, v96
    v_dot2_f32_bf16 v96, v195, v195, v96
    v_mfma_f32_16x16x32_bf16 v[72:75], v[192:195], v[12:15], 0
    v_lshlrev_b32 v100, 16, v196
    v_and_b32 v101, 0xffff0000, v196
    v_lshlrev_b32 v102, 16, v197
    v_and_b32 v103, 0xffff0000, v197
    v_lshlrev_b32 v104, 16, v198
    v_and_b32 v105, 0xffff0000, v198
    v_lshlrev_b32 v106, 16, v199
    v_and_b32 v107, 0xffff0000, v199
    v_pk_mul_f32 v[100:101], v[100:101], s[52:53]
    v_pk_mul_f32 v[102:103], v[102:103], s[52:53]
    v_pk_mul_f32 v[104:105], v[104:105], s[52:53]
    v_pk_mul_f32 v[106:107], v[106:107], s[52:53]
    v_cvt_pk_bf16_f32 v196, v100, v101
    v_cvt_pk_bf16_f32 v197, v102, v103
    v_cvt_pk_bf16_f32 v198, v104, v105
    v_cvt_pk_bf16_f32 v199, v106, v107
    v_dot2_f32_bf16 v96, v196, v196, v96
    v_dot2_f32_bf16 v96, v197, v197, v96
    v_dot2_f32_bf16 v96, v198, v198, v96
    v_dot2_f32_bf16 v96, v199, v199, v96
    v_mfma_f32_16x16x32_bf16 v[72:75], v[196:199], v[16:19], v[72:75]
    v_lshlrev_b32 v100, 16, v200
    v_and_b32 v101, 0xffff0000, v200
    v_lshlrev_b32 v102, 16, v201
    v_and_b32 v103, 0xffff0000, v201
    v_lshlrev_b32 v104, 16, v202
    v_and_b32 v105, 0xffff0000, v202
    v_lshlrev_b32 v106, 16, v203
    v_and_b32 v107, 0xffff0000, v203
    v_pk_mul_f32 v[100:101], v[100:101], s[52:53]
    v_pk_mul_f32 v[102:103], v[102:103], s[52:53]
    v_pk_mul_f32 v[104:105], v[104:105], s[52:53]
    v_pk_mul_f32 v[106:107], v[106:107], s[52:53]
    v_cvt_pk_bf16_f32 v200, v100, v101
    v_cvt_pk_bf16_f32 v201, v102, v103
    v_cvt_pk_bf16_f32 v202, v104, v105
    v_cvt_pk_bf16_f32 v203, v106, v107
    v_dot2_f32_bf16 v97, v200, v200, 0
    v_dot2_f32_bf16 v97, v201, v201, v97
    v_dot2_f32_bf16 v97, v202, v202, v97
    v_dot2_f32_bf16 v97, v203, v203, v97
    v_mfma_f32_16x16x32_bf16 v[76:79], v[200:203], v[12:15], 0
    v_lshlrev_b32 v100, 16, v204
    v_and_b32 v101, 0xffff0000, v204
    v_lshlrev_b32 v102, 16, v205
    v_and_b32 v103, 0xffff0000, v205
    v_lshlrev_b32 v104, 16, v206
    v_and_b32 v105, 0xffff0000, v206
    v_lshlrev_b32 v106, 16, v207
    v_and_b32 v107, 0xffff0000, v207
    v_pk_mul_f32 v[100:101], v[100:101], s[52:53]
    v_pk_mul_f32 v[102:103], v[102:103], s[52:53]
    v_pk_mul_f32 v[104:105], v[104:105], s[52:53]
    v_pk_mul_f32 v[106:107], v[106:107], s[52:53]
    v_cvt_pk_bf16_f32 v204, v100, v101
    v_cvt_pk_bf16_f32 v205, v102, v103
    v_cvt_pk_bf16_f32 v206, v104, v105
    v_cvt_pk_bf16_f32 v207, v106, v107
    v_dot2_f32_bf16 v97, v204, v204, v97
    v_dot2_f32_bf16 v97, v205, v205, v97
    v_dot2_f32_bf16 v97, v206, v206, v97
    v_dot2_f32_bf16 v97, v207, v207, v97
    v_mfma_f32_16x16x32_bf16 v[76:79], v[204:207], v[16:19], v[76:79]
    v_add_f32_dpp v96, v96, v96 row_ror:8 row_mask:0xf bank_mask:0xf
    s_nop 0
    v_add_f32_dpp v97, v97, v97 row_ror:8 row_mask:0xf bank_mask:0xf
    s_nop 1
    v_mov_b32_dpp v96, v97 quad_perm:[0,1,2,3] row_mask:0xf bank_mask:0xc
    s_nop 1
    v_mfma_f32_16x16x4_f32 v[88:91], v96, v5, 0
    s_waitcnt vmcnt(8)
    buffer_load_dwordx4 v[160:163], v3, s[24:27], s67 offen offset:0 nt
    buffer_load_dwordx4 v[164:167], v3, s[24:27], s67 offen offset:2048 nt
    buffer_load_dwordx4 v[168:171], v3, s[24:27], s71 offen offset:0 nt
    buffer_load_dwordx4 v[172:175], v3, s[24:27], s71 offen offset:2048 nt
    buffer_load_dwordx4 v[176:179], v3, s[24:27], s67 offen offset:1024 nt
    buffer_load_dwordx4 v[180:183], v3, s[24:27], s67 offen offset:3072 nt
    buffer_load_dwordx4 v[184:187], v3, s[24:27], s71 offen offset:1024 nt
    buffer_load_dwordx4 v[188:191], v3, s[24:27], s71 offen offset:3072 nt
    v_lshlrev_b32 v108, 16, v208
    v_and_b32 v109, 0xffff0000, v208
    v_lshlrev_b32 v110, 16, v209
    v_and_b32 v111, 0xffff0000, v209
    v_lshlrev_b32 v112, 16, v210
    v_and_b32 v113, 0xffff0000, v210
    v_lshlrev_b32 v114, 16, v211
    v_and_b32 v115, 0xffff0000, v211
    v_pk_mul_f32 v[108:109], v[108:109], s[52:53]
    v_pk_mul_f32 v[110:111], v[110:111], s[52:53]
    v_pk_mul_f32 v[112:113], v[112:113], s[52:53]
    v_pk_mul_f32 v[114:115], v[114:115], s[52:53]
    v_cvt_pk_bf16_f32 v208, v108, v109
    v_cvt_pk_bf16_f32 v209, v110, v111
    v_cvt_pk_bf16_f32 v210, v112, v113
    v_cvt_pk_bf16_f32 v211, v114, v115
    v_dot2_f32_bf16 v98, v208, v208, 0
    v_dot2_f32_bf16 v98, v209, v209, v98
    v_dot2_f32_bf16 v98, v210, v210, v98
    v_dot2_f32_bf16 v98, v211, v211, v98
    v_mfma_f32_16x16x32_bf16 v[80:83], v[208:211], v[12:15], 0
    v_lshlrev_b32 v108, 16, v212
    v_and_b32 v109, 0xffff0000, v212
    v_lshlrev_b32 v110, 16, v213
    v_and_b32 v111, 0xffff0000, v213
    v_lshlrev_b32 v112, 16, v214
    v_and_b32 v113, 0xffff0000, v214
    v_lshlrev_b32 v114, 16, v215
    v_and_b32 v115, 0xffff0000, v215
    v_pk_mul_f32 v[108:109], v[108:109], s[52:53]
    v_pk_mul_f32 v[110:111], v[110:111], s[52:53]
    v_pk_mul_f32 v[112:113], v[112:113], s[52:53]
    v_pk_mul_f32 v[114:115], v[114:115], s[52:53]
    v_cvt_pk_bf16_f32 v212, v108, v109
    v_cvt_pk_bf16_f32 v213, v110, v111
    v_cvt_pk_bf16_f32 v214, v112, v113
    v_cvt_pk_bf16_f32 v215, v114, v115
    v_dot2_f32_bf16 v98, v212, v212, v98
    v_dot2_f32_bf16 v98, v213, v213, v98
    v_dot2_f32_bf16 v98, v214, v214, v98
    v_dot2_f32_bf16 v98, v215, v215, v98
    v_mfma_f32_16x16x32_bf16 v[80:83], v[212:215], v[16:19], v[80:83]
    v_lshlrev_b32 v108, 16, v216
    v_and_b32 v109, 0xffff0000, v216
    v_lshlrev_b32 v110, 16, v217
    v_and_b32 v111, 0xffff0000, v217
    v_lshlrev_b32 v112, 16, v218
    v_and_b32 v113, 0xffff0000, v218
    v_lshlrev_b32 v114, 16, v219
    v_and_b32 v115, 0xffff0000, v219
    v_pk_mul_f32 v[108:109], v[108:109], s[52:53]
    v_pk_mul_f32 v[110:111], v[110:111], s[52:53]
    v_pk_mul_f32 v[112:113], v[112:113], s[52:53]
    v_pk_mul_f32 v[114:115], v[114:115], s[52:53]
    v_cvt_pk_bf16_f32 v216, v108, v109
    v_cvt_pk_bf16_f32 v217, v110, v111
    v_cvt_pk_bf16_f32 v218, v112, v113
    v_cvt_pk_bf16_f32 v219, v114, v115
    v_dot2_f32_bf16 v99, v216, v216, 0
    v_dot2_f32_bf16 v99, v217, v217, v99
    v_dot2_f32_bf16 v99, v218, v218, v99
    v_dot2_f32_bf16 v99, v219, v219, v99
    v_mfma_f32_16x16x32_bf16 v[84:87], v[216:219], v[12:15], 0
    v_lshlrev_b32 v108, 16, v220
    v_and_b32 v109, 0xffff0000, v220
    v_lshlrev_b32 v110, 16, v221
    v_and_b32 v111, 0xffff0000, v221
    v_lshlrev_b32 v112, 16, v222
    v_and_b32 v113, 0xffff0000, v222
    v_lshlrev_b32 v114, 16, v223
    v_and_b32 v115, 0xffff0000, v223
    v_pk_mul_f32 v[108:109], v[108:109], s[52:53]
    v_pk_mul_f32 v[110:111], v[110:111], s[52:53]
    v_pk_mul_f32 v[112:113], v[112:113], s[52:53]
    v_pk_mul_f32 v[114:115], v[114:115], s[52:53]
    v_cvt_pk_bf16_f32 v220, v108, v109
    v_cvt_pk_bf16_f32 v221, v110, v111
    v_cvt_pk_bf16_f32 v222, v112, v113
    v_cvt_pk_bf16_f32 v223, v114, v115
    v_dot2_f32_bf16 v99, v220, v220, v99
    v_dot2_f32_bf16 v99, v221, v221, v99
    v_dot2_f32_bf16 v99, v222, v222, v99
    v_dot2_f32_bf16 v99, v223, v223, v99
    v_mfma_f32_16x16x32_bf16 v[84:87], v[220:223], v[16:19], v[84:87]
    v_add_f32_dpp v98, v98, v98 row_ror:8 row_mask:0xf bank_mask:0xf
    s_nop 0
    v_add_f32_dpp v99, v99, v99 row_ror:8 row_mask:0xf bank_mask:0xf
    s_nop 1
    v_mov_b32_dpp v98, v99 quad_perm:[0,1,2,3] row_mask:0xf bank_mask:0xc
    s_nop 1
    v_mfma_f32_16x16x4_f32 v[92:95], v98, v5, 0
    v_permlane32_swap_b32 v72, v76
    v_permlane32_swap_b32 v73, v77
    v_permlane32_swap_b32 v74, v78
    v_permlane32_swap_b32 v75, v79
    v_add_f32_dpp v72, v76, v72 row_ror:8 row_mask:0xf bank_mask:0xf
    v_add_f32_dpp v73, v77, v73 row_ror:8 row_mask:0xf bank_mask:0xf
    v_add_f32_dpp v74, v78, v74 row_ror:8 row_mask:0xf bank_mask:0xf
    v_add_f32_dpp v75, v79, v75 row_ror:8 row_mask:0xf bank_mask:0xf
    v_cvt_pk_bf16_f32 v116, v72, v73
    v_cvt_pk_bf16_f32 v117, v74, v75
    v_lshlrev_b32 v72, 16, v116
    v_and_b32 v73, 0xffff0000, v116
    v_lshlrev_b32 v74, 16, v117
    v_and_b32 v75, 0xffff0000, v117
    v_cvt_pk_bf16_f32 v118, v88, v89
    v_cvt_pk_bf16_f32 v119, v90, v91
    v_lshlrev_b32 v88, 16, v118
    v_and_b32 v89, 0xffff0000, v118
    v_lshlrev_b32 v90, 16, v119
    v_and_b32 v91, 0xffff0000, v119
    v_fma_f32 v72, v88, -0.5, v72
    v_fma_f32 v73, v89, -0.5, v73
    v_fma_f32 v74, v90, -0.5, v74
    v_fma_f32 v75, v91, -0.5, v75
    v_cvt_pk_bf16_f32 v116, v72, v73
    v_cvt_pk_bf16_f32 v117, v74, v75
    v_lshlrev_b32 v72, 16, v116
    v_and_b32 v73, 0xffff0000, v116
    v_lshlrev_b32 v74, 16, v117
    v_and_b32 v75, 0xffff0000, v117
    v_med3_f32 v72, v72, v6, s61
    v_med3_f32 v73, v73, v6, s61
    v_med3_f32 v74, v74, v6, s61
    v_med3_f32 v75, v75, v6, s61
    v_mul_f32 v88, s56, v72
    v_mul_f32 v89, s56, v73
    v_mul_f32 v90, s56, v74
    v_mul_f32 v91, s56, v75
    v_rndne_f32 v116, v88
    v_rndne_f32 v117, v89
    v_rndne_f32 v118, v90
    v_rndne_f32 v119, v91
    v_sub_f32 v88, v88, v116
    v_sub_f32 v89, v89, v117
    v_sub_f32 v90, v90, v118
    v_sub_f32 v91, v91, v119
    v_fma_f32 v88, v72, s57, v88
    v_fma_f32 v89, v73, s57, v89
    v_fma_f32 v90, v74, s57, v90
    v_fma_f32 v91, v75, s57, v91
    v_cvt_i32_f32 v116, v116
    v_cvt_i32_f32 v117, v117
    v_cvt_i32_f32 v118, v118
    v_cvt_i32_f32 v119, v119
    v_exp_f32 v88, v88
    v_exp_f32 v89, v89
    v_exp_f32 v90, v90
    v_exp_f32 v91, v91
    v_ldexp_f32 v72, v88, v116
    v_ldexp_f32 v73, v89, v117
    v_ldexp_f32 v74, v90, v118
    v_ldexp_f32 v75, v91, v119
    v_cvt_pk_bf16_f32 v116, v72, v73
    v_cvt_pk_bf16_f32 v117, v74, v75
    v_lshlrev_b32 v72, 16, v116
    v_and_b32 v73, 0xffff0000, v116
    v_lshlrev_b32 v74, 16, v117
    v_and_b32 v75, 0xffff0000, v117
    v_mul_f32 v72, s58, v72
    v_mul_f32 v73, s58, v73
    v_mul_f32 v74, s58, v74
    v_mul_f32 v75, s58, v75
    v_cvt_pk_bf16_f32 v116, v72, v73
    v_cvt_pk_bf16_f32 v117, v74, v75
    v_lshlrev_b32 v72, 16, v116
    v_and_b32 v73, 0xffff0000, v116
    v_lshlrev_b32 v74, 16, v117
    v_and_b32 v75, 0xffff0000, v117
    v_add_f32 v72, s59, v72
    v_add_f32 v73, s59, v73
    v_add_f32 v74, s59, v74
    v_add_f32 v75, s59, v75
    v_cvt_pk_bf16_f32 v68, v72, v73
    v_cvt_pk_bf16_f32 v69, v74, v75
    v_permlane32_swap_b32 v80, v84
    v_permlane32_swap_b32 v81, v85
    v_permlane32_swap_b32 v82, v86
    v_permlane32_swap_b32 v83, v87
    v_add_f32_dpp v80, v84, v80 row_ror:8 row_mask:0xf bank_mask:0xf
    v_add_f32_dpp v81, v85, v81 row_ror:8 row_mask:0xf bank_mask:0xf
    v_add_f32_dpp v82, v86, v82 row_ror:8 row_mask:0xf bank_mask:0xf
    v_add_f32_dpp v83, v87, v83 row_ror:8 row_mask:0xf bank_mask:0xf
    v_cvt_pk_bf16_f32 v116, v80, v81
    v_cvt_pk_bf16_f32 v117, v82, v83
    v_lshlrev_b32 v80, 16, v116
    v_and_b32 v81, 0xffff0000, v116
    v_lshlrev_b32 v82, 16, v117
    v_and_b32 v83, 0xffff0000, v117
    v_cvt_pk_bf16_f32 v118, v92, v93
    v_cvt_pk_bf16_f32 v119, v94, v95
    v_lshlrev_b32 v92, 16, v118
    v_and_b32 v93, 0xffff0000, v118
    v_lshlrev_b32 v94, 16, v119
    v_and_b32 v95, 0xffff0000, v119
    v_fma_f32 v80, v92, -0.5, v80
    v_fma_f32 v81, v93, -0.5, v81
    v_fma_f32 v82, v94, -0.5, v82
    v_fma_f32 v83, v95, -0.5, v83
    v_cvt_pk_bf16_f32 v116, v80, v81
    v_cvt_pk_bf16_f32 v117, v82, v83
    v_lshlrev_b32 v80, 16, v116
    v_and_b32 v81, 0xffff0000, v116
    v_lshlrev_b32 v82, 16, v117
    v_and_b32 v83, 0xffff0000, v117
    v_med3_f32 v80, v80, v6, s61
    v_med3_f32 v81, v81, v6, s61
    v_med3_f32 v82, v82, v6, s61
    v_med3_f32 v83, v83, v6, s61
    v_mul_f32 v92, s56, v80
    v_mul_f32 v93, s56, v81
    v_mul_f32 v94, s56, v82
    v_mul_f32 v95, s56, v83
    v_rndne_f32 v116, v92
    v_rndne_f32 v117, v93
    v_rndne_f32 v118, v94
    v_rndne_f32 v119, v95
    v_sub_f32 v92, v92, v116
    v_sub_f32 v93, v93, v117
    v_sub_f32 v94, v94, v118
    v_sub_f32 v95, v95, v119
    v_fma_f32 v92, v80, s57, v92
    v_fma_f32 v93, v81, s57, v93
    v_fma_f32 v94, v82, s57, v94
    v_fma_f32 v95, v83, s57, v95
    v_cvt_i32_f32 v116, v116
    v_cvt_i32_f32 v117, v117
    v_cvt_i32_f32 v118, v118
    v_cvt_i32_f32 v119, v119
    v_exp_f32 v92, v92
    v_exp_f32 v93, v93
    v_exp_f32 v94, v94
    v_exp_f32 v95, v95
    v_ldexp_f32 v80, v92, v116
    v_ldexp_f32 v81, v93, v117
    v_ldexp_f32 v82, v94, v118
    v_ldexp_f32 v83, v95, v119
    v_cvt_pk_bf16_f32 v116, v80, v81
    v_cvt_pk_bf16_f32 v117, v82, v83
    v_lshlrev_b32 v80, 16, v116
    v_and_b32 v81, 0xffff0000, v116
    v_lshlrev_b32 v82, 16, v117
    v_and_b32 v83, 0xffff0000, v117
    v_mul_f32 v80, s58, v80
    v_mul_f32 v81, s58, v81
    v_mul_f32 v82, s58, v82
    v_mul_f32 v83, s58, v83
    v_cvt_pk_bf16_f32 v116, v80, v81
    v_cvt_pk_bf16_f32 v117, v82, v83
    v_lshlrev_b32 v80, 16, v116
    v_and_b32 v81, 0xffff0000, v116
    v_lshlrev_b32 v82, 16, v117
    v_and_b32 v83, 0xffff0000, v117
    v_add_f32 v80, s59, v80
    v_add_f32 v81, s59, v81
    v_add_f32 v82, s59, v82
    v_add_f32 v83, s59, v83
    v_cvt_pk_bf16_f32 v70, v80, v81
    v_cvt_pk_bf16_f32 v71, v82, v83
    v_mov_b32 v192, 1
    s_lshl_b32 s3, s49, 2
    v_mov_b32 v193, s3
    s_barrier
    s_cmp_lg_u32 s48, 0
    s_cbranch_scc1 L_noarr
    s_mov_b64 exec, 1
    buffer_atomic_add v192, v193, s[44:47], 0 offen sc0
    s_mov_b64 exec, -1
L_noarr:
    s_cmp_lg_u32 s48, 0
    s_cbranch_scc1 L_w2a
    s_waitcnt vmcnt(9)
    s_branch L_w2b
L_w2a:
    s_waitcnt vmcnt(8)
L_w2b:
    v_mfma_f32_16x16x32_bf16 v[52:55], v[64:67], v[8:11], v[52:55]
    v_perm_b32 v100, v132, v128, s54
    v_perm_b32 v104, v132, v128, s55
    v_perm_b32 v101, v140, v136, s54
    v_perm_b32 v105, v140, v136, s55
    v_perm_b32 v102, v148, v144, s54
    v_perm_b32 v106, v148, v144, s55
    v_perm_b32 v103, v156, v152, s54
    v_perm_b32 v107, v156, v152, s55
    s_nop 0
    v_mfma_f32_16x16x32_bf16 v[20:23], v[64:67], v[100:103], v[20:23]
    v_mfma_f32_16x16x32_bf16 v[24:27], v[64:67], v[104:107], v[24:27]
    v_perm_b32 v108, v133, v129, s54
    v_perm_b32 v112, v133, v129, s55
    v_perm_b32 v109, v141, v137, s54
    v_perm_b32 v113, v141, v137, s55
    v_perm_b32 v110, v149, v145, s54
    v_perm_b32 v114, v149, v145, s55
    v_perm_b32 v111, v157, v153, s54
    v_perm_b32 v115, v157, v153, s55
    s_nop 0
    v_mfma_f32_16x16x32_bf16 v[28:31], v[64:67], v[108:111], v[28:31]
    v_mfma_f32_16x16x32_bf16 v[32:35], v[64:67], v[112:115], v[32:35]
    v_perm_b32 v100, v134, v130, s54
    v_perm_b32 v104, v134, v130, s55
    v_perm_b32 v101, v142, v138, s54
    v_perm_b32 v105, v142, v138, s55
    v_perm_b32 v102, v150, v146, s54
    v_perm_b32 v106, v150, v146, s55
    v_perm_b32 v103, v158, v154, s54
    v_perm_b32 v107, v158, v154, s55
    s_nop 0
    v_mfma_f32_16x16x32_bf16 v[36:39], v[64:67], v[100:103], v[36:39]
    v_mfma_f32_16x16x32_bf16 v[40:43], v[64:67], v[104:107], v[40:43]
    v_perm_b32 v108, v135, v131, s54
    v_perm_b32 v112, v135, v131, s55
    v_perm_b32 v109, v143, v139, s54
    v_perm_b32 v113, v143, v139, s55
    v_perm_b32 v110, v151, v147, s54
    v_perm_b32 v114, v151, v147, s55
    v_perm_b32 v111, v159, v155, s54
    v_perm_b32 v115, v159, v155, s55
    s_nop 0
    v_mfma_f32_16x16x32_bf16 v[44:47], v[64:67], v[108:111], v[44:47]
    v_mfma_f32_16x16x32_bf16 v[48:51], v[64:67], v[112:115], v[48:51]
    s_waitcnt vmcnt(0)
    v_mov_b32 v194, 33024
    s_cmp_lg_u32 s48, 0
    s_cbranch_scc1 L_nobc
    s_mov_b64 exec, 1
    ds_write_b32 v194, v192
    s_mov_b64 exec, -1
L_nobc:
    v_mfma_f32_16x16x32_bf16 v[52:55], v[68:71], v[8:11], v[52:55]
    v_perm_b32 v100, v164, v160, s54
    v_perm_b32 v104, v164, v160, s55
    v_perm_b32 v101, v172, v168, s54
    v_perm_b32 v105, v172, v168, s55
    v_perm_b32 v102, v180, v176, s54
    v_perm_b32 v106, v180, v176, s55
    v_perm_b32 v103, v188, v184, s54
    v_perm_b32 v107, v188, v184, s55
    s_nop 0
    v_mfma_f32_16x16x32_bf16 v[20:23], v[68:71], v[100:103], v[20:23]
    v_mfma_f32_16x16x32_bf16 v[24:27], v[68:71], v[104:107], v[24:27]
    v_perm_b32 v108, v165, v161, s54
    v_perm_b32 v112, v165, v161, s55
    v_perm_b32 v109, v173, v169, s54
    v_perm_b32 v113, v173, v169, s55
    v_perm_b32 v110, v181, v177, s54
    v_perm_b32 v114, v181, v177, s55
    v_perm_b32 v111, v189, v185, s54
    v_perm_b32 v115, v189, v185, s55
    s_nop 0
    v_mfma_f32_16x16x32_bf16 v[28:31], v[68:71], v[108:111], v[28:31]
    v_mfma_f32_16x16x32_bf16 v[32:35], v[68:71], v[112:115], v[32:35]
    v_perm_b32 v100, v166, v162, s54
    v_perm_b32 v104, v166, v162, s55
    v_perm_b32 v101, v174, v170, s54
    v_perm_b32 v105, v174, v170, s55
    v_perm_b32 v102, v182, v178, s54
    v_perm_b32 v106, v182, v178, s55
    v_perm_b32 v103, v190, v186, s54
    v_perm_b32 v107, v190, v186, s55
    s_nop 0
    v_mfma_f32_16x16x32_bf16 v[36:39], v[68:71], v[100:103], v[36:39]
    v_mfma_f32_16x16x32_bf16 v[40:43], v[68:71], v[104:107], v[40:43]
    v_perm_b32 v108, v167, v163, s54
    v_perm_b32 v112, v167, v163, s55
    v_perm_b32 v109, v175, v171, s54
    v_perm_b32 v113, v175, v171, s55
    v_perm_b32 v110, v183, v179, s54
    v_perm_b32 v114, v183, v179, s55
    v_perm_b32 v111, v191, v187, s54
    v_perm_b32 v115, v191, v187, s55
    s_nop 0
    v_mfma_f32_16x16x32_bf16 v[44:47], v[68:71], v[108:111], v[44:47]
    v_mfma_f32_16x16x32_bf16 v[48:51], v[68:71], v[112:115], v[48:51]
    s_lshl_b32 s3, s48, 12
    v_add_u32 v100, s3, v3
    s_lshl_b32 s3, s48, 5
    v_add_u32 v101, s3, v1
    s_mov_b64 exec, 0x00010001
    ds_write_b128 v101, v[52:55] offset:32768
    s_mov_b64 exec, -1
    v_permlane32_swap_b32 v20, v24
    v_permlane32_swap_b32 v21, v25
    v_permlane32_swap_b32 v22, v26
    v_permlane32_swap_b32 v23, v27
    ds_write_b128 v100, v[20:23] offset:0
    v_permlane32_swap_b32 v28, v32
    v_permlane32_swap_b32 v29, v33
    v_permlane32_swap_b32 v30, v34
    v_permlane32_swap_b32 v31, v35
    ds_write_b128 v100, v[28:31] offset:1024
    v_permlane32_swap_b32 v36, v40
    v_permlane32_swap_b32 v37, v41
    v_permlane32_swap_b32 v38, v42
    v_permlane32_swap_b32 v39, v43
    ds_write_b128 v100, v[36:39] offset:2048
    v_permlane32_swap_b32 v44, v48
    v_permlane32_swap_b32 v45, v49
    v_permlane32_swap_b32 v46, v50
    v_permlane32_swap_b32 v47, v51
    ds_write_b128 v100, v[44:47] offset:3072
    s_lshl_b32 s3, s48, 9
    v_add_u32 v102, s3, v124
    s_waitcnt lgkmcnt(0)
    s_barrier
    s_memrealtime s[72:73]
    ds_read_b32 v101, v194
    s_mov_b32 s62, 64
    s_waitcnt lgkmcnt(0)
    v_readfirstlane_b32 s63, v101
    ds_read_b64 v[128:129], v102 offset:0
    ds_read_b64 v[130:131], v125 offset:32768
    ds_read_b64 v[132:133], v102 offset:4096
    ds_read_b64 v[134:135], v125 offset:32800
    s_and_b32 s63, s63, 0xff
    s_cmp_lg_u32 s63, 3
    s_cbranch_scc1 L_red0
    s_add_u32 s3, s51, 0
    buffer_load_dwordx4 v[224:227], v3, s[36:39], s3 offen sc1
    buffer_load_dwordx4 v[228:231], v4, s[36:39], s3 offen offset:1024 sc1
    s_add_u32 s3, s51, 16384
    buffer_load_dwordx4 v[232:235], v3, s[36:39], s3 offen sc1
    buffer_load_dwordx4 v[236:239], v4, s[36:39], s3 offen offset:1024 sc1
    s_add_u32 s3, s51, 32768
    buffer_load_dwordx4 v[240:243], v3, s[36:39], s3 offen sc1
    buffer_load_dwordx4 v[244:247], v4, s[36:39], s3 offen offset:1024 sc1
    s_add_u32 s3, s51, 49152
    buffer_load_dwordx4 v[248:251], v3, s[36:39], s3 offen sc1
    buffer_load_dwordx4 v[252:255], v4, s[36:39], s3 offen offset:1024 sc1
L_red0:
    ds_read_b64 v[136:137], v102 offset:8192
    ds_read_b64 v[138:139], v125 offset:32832
    ds_read_b64 v[140:141], v102 offset:12288
    ds_read_b64 v[142:143], v125 offset:32864
    ds_read_b64 v[144:145], v102 offset:16384
    ds_read_b64 v[146:147], v125 offset:32896
    ds_read_b64 v[148:149], v102 offset:20480
    ds_read_b64 v[150:151], v125 offset:32928
    ds_read_b64 v[152:153], v102 offset:24576
    ds_read_b64 v[154:155], v125 offset:32960
    ds_read_b64 v[156:157], v102 offset:28672
    ds_read_b64 v[158:159], v125 offset:32992
    s_waitcnt lgkmcnt(0)
L_red:
    v_add_f32 v20, v128, v132
    v_add_f32 v21, v129, v133
    v_add_f32 v24, v130, v134
    v_add_f32 v25, v131, v135
    v_add_f32 v20, v20, v136
    v_add_f32 v21, v21, v137
    v_add_f32 v24, v24, v138
    v_add_f32 v25, v25, v139
    v_add_f32 v20, v20, v140
    v_add_f32 v21, v21, v141
    v_add_f32 v24, v24, v142
    v_add_f32 v25, v25, v143
    v_add_f32 v20, v20, v144
    v_add_f32 v21, v21, v145
    v_add_f32 v24, v24, v146
    v_add_f32 v25, v25, v147
    v_add_f32 v20, v20, v148
    v_add_f32 v21, v21, v149
    v_add_f32 v24, v24, v150
    v_add_f32 v25, v25, v151
    v_add_f32 v20, v20, v152
    v_add_f32 v21, v21, v153
    v_add_f32 v24, v24, v154
    v_add_f32 v25, v25, v155
    v_add_f32 v20, v20, v156
    v_add_f32 v21, v21, v157
    v_add_f32 v24, v24, v158
    v_add_f32 v25, v25, v159
    v_mov_b32 v22, s72
    v_mov_b32 v23, s73
    v_mov_b32 v26, s72
    v_mov_b32 v27, s73
    s_cmp_lg_u32 s63, 3
    s_cbranch_scc1 L_notlast
    s_branch L_spin1
L_spin:
    s_add_u32 s3, s51, 0
    buffer_load_dwordx4 v[224:227], v3, s[36:39], s3 offen sc1
    buffer_load_dwordx4 v[228:231], v4, s[36:39], s3 offen offset:1024 sc1
    s_add_u32 s3, s51, 16384
    buffer_load_dwordx4 v[232:235], v3, s[36:39], s3 offen sc1
    buffer_load_dwordx4 v[236:239], v4, s[36:39], s3 offen offset:1024 sc1
    s_add_u32 s3, s51, 32768
    buffer_load_dwordx4 v[240:243], v3, s[36:39], s3 offen sc1
    buffer_load_dwordx4 v[244:247], v4, s[36:39], s3 offen offset:1024 sc1
    s_add_u32 s3, s51, 49152
    buffer_load_dwordx4 v[248:251], v3, s[36:39], s3 offen sc1
    buffer_load_dwordx4 v[252:255], v4, s[36:39], s3 offen offset:1024 sc1
L_spin1:
    s_waitcnt vmcnt(0)
    s_cmp_lg_u32 s50, 0
    s_cbranch_scc1 L_owne_0
    v_mov_b32 v224, v20
    v_mov_b32 v225, v21
    v_mov_b32 v226, v22
    v_mov_b32 v227, v23
    v_mov_b32 v228, v24
    v_mov_b32 v229, v25
    v_mov_b32 v230, v26
    v_mov_b32 v231, v27
L_owne_0:
    s_cmp_lg_u32 s50, 1
    s_cbranch_scc1 L_owne_1
    v_mov_b32 v232, v20
    v_mov_b32 v233, v21
    v_mov_b32 v234, v22
    v_mov_b32 v235, v23
    v_mov_b32 v236, v24
    v_mov_b32 v237, v25
    v_mov_b32 v238, v26
    v_mov_b32 v239, v27
L_owne_1:
    s_cmp_lg_u32 s50, 2
    s_cbranch_scc1 L_owne_2
    v_mov_b32 v240, v20
    v_mov_b32 v241, v21
    v_mov_b32 v242, v22
    v_mov_b32 v243, v23
    v_mov_b32 v244, v24
    v_mov_b32 v245, v25
    v_mov_b32 v246, v26
    v_mov_b32 v247, v27
L_owne_2:
    s_cmp_lg_u32 s50, 3
    s_cbranch_scc1 L_owne_3
    v_mov_b32 v248, v20
    v_mov_b32 v249, v21
    v_mov_b32 v250, v22
    v_mov_b32 v251, v23
    v_mov_b32 v252, v24
    v_mov_b32 v253, v25
    v_mov_b32 v254, v26
    v_mov_b32 v255, v27
L_owne_3:
    v_sub_co_u32 v112, s[74:75], v226, v7
    v_sub_co_u32 v113, s[76:77], v230, v7
    v_sub_co_u32 v114, s[78:79], v234, v7
    v_sub_co_u32 v115, s[80:81], v238, v7
    v_subb_co_u32 v116, s[74:75], v227, v0, s[74:75]
    v_subb_co_u32 v117, s[76:77], v231, v0, s[76:77]
    v_subb_co_u32 v118, s[78:79], v235, v0, s[78:79]
    v_subb_co_u32 v119, s[80:81], v239, v0, s[80:81]
    v_lshrrev_b32 v112, 24, v112
    v_lshrrev_b32 v113, 24, v113
    v_lshrrev_b32 v114, 24, v114
    v_lshrrev_b32 v115, 24, v115
    v_or_b32 v105, v116, v112
    v_or3_b32 v105, v105, v117, v113
    v_or3_b32 v105, v105, v118, v114
    v_or3_b32 v105, v105, v119, v115
    v_sub_co_u32 v112, s[74:75], v242, v7
    v_sub_co_u32 v113, s[76:77], v246, v7
    v_sub_co_u32 v114, s[78:79], v250, v7
    v_sub_co_u32 v115, s[80:81], v254, v7
    v_subb_co_u32 v116, s[74:75], v243, v0, s[74:75]
    v_subb_co_u32 v117, s[76:77], v247, v0, s[76:77]
    v_subb_co_u32 v118, s[78:79], v251, v0, s[78:79]
    v_subb_co_u32 v119, s[80:81], v255, v0, s[80:81]
    v_lshrrev_b32 v112, 24, v112
    v_lshrrev_b32 v113, 24, v113
    v_lshrrev_b32 v114, 24, v114
    v_lshrrev_b32 v115, 24, v115
    v_or3_b32 v105, v105, v116, v112
    v_or3_b32 v105, v105, v117, v113
    v_or3_b32 v105, v105, v118, v114
    v_or3_b32 v105, v105, v119, v115
    v_cmp_ne_u32 vcc, 0, v105
    v_add_f32 v108, v224, v232
    v_add_f32 v109, v225, v233
    v_add_f32 v110, v228, v236
    v_add_f32 v111, v229, v237
    v_add_f32 v108, v108, v240
    v_add_f32 v109, v109, v241
    v_add_f32 v110, v110, v244
    v_add_f32 v111, v111, v245
    v_add_f32 v108, v108, v248
    v_add_f32 v109, v109, v249
    v_add_f32 v110, v110, v252
    v_add_f32 v111, v111, v253
    s_cbranch_vccz L_final
    s_sub_u32 s62, s62, 1
    s_cmp_lg_u32 s62, 0
    s_cbranch_scc1 L_spin
L_rare:
    buffer_load_dword v101, v193, s[44:47], 0 offen sc1
    s_waitcnt vmcnt(0)
    v_readfirstlane_b32 s3, v101
    s_nop 3
    s_bfe_u32 s3, s3, 0x80008
    s_cmp_lg_u32 s3, 3
    s_cbranch_scc0 L_rare2
    s_sleep 8
    s_branch L_rare
L_rare2:
    s_add_u32 s3, s51, 0
    buffer_load_dwordx4 v[224:227], v3, s[36:39], s3 offen sc1
    buffer_load_dwordx4 v[228:231], v4, s[36:39], s3 offen offset:1024 sc1
    s_add_u32 s3, s51, 16384
    buffer_load_dwordx4 v[232:235], v3, s[36:39], s3 offen sc1
    buffer_load_dwordx4 v[236:239], v4, s[36:39], s3 offen offset:1024 sc1
    s_add_u32 s3, s51, 32768
    buffer_load_dwordx4 v[240:243], v3, s[36:39], s3 offen sc1
    buffer_load_dwordx4 v[244:247], v4, s[36:39], s3 offen offset:1024 sc1
    s_add_u32 s3, s51, 49152
    buffer_load_dwordx4 v[248:251], v3, s[36:39], s3 offen sc1
    buffer_load_dwordx4 v[252:255], v4, s[36:39], s3 offen offset:1024 sc1
    s_waitcnt vmcnt(0)
    s_cmp_lg_u32 s50, 0
    s_cbranch_scc1 L_ownt_0
    v_mov_b32 v224, v20
    v_mov_b32 v225, v21
    v_mov_b32 v226, v22
    v_mov_b32 v227, v23
    v_mov_b32 v228, v24
    v_mov_b32 v229, v25
    v_mov_b32 v230, v26
    v_mov_b32 v231, v27
L_ownt_0:
    s_cmp_lg_u32 s50, 1
    s_cbranch_scc1 L_ownt_1
    v_mov_b32 v232, v20
    v_mov_b32 v233, v21
    v_mov_b32 v234, v22
    v_mov_b32 v235, v23
    v_mov_b32 v236, v24
    v_mov_b32 v237, v25
    v_mov_b32 v238, v26
    v_mov_b32 v239, v27
L_ownt_1:
    s_cmp_lg_u32 s50, 2
    s_cbranch_scc1 L_ownt_2
    v_mov_b32 v240, v20
    v_mov_b32 v241, v21
    v_mov_b32 v242, v22
    v_mov_b32 v243, v23
    v_mov_b32 v244, v24
    v_mov_b32 v245, v25
    v_mov_b32 v246, v26
    v_mov_b32 v247, v27
L_ownt_2:
    s_cmp_lg_u32 s50, 3
    s_cbranch_scc1 L_ownt_3
    v_mov_b32 v248, v20
    v_mov_b32 v249, v21
    v_mov_b32 v250, v22
    v_mov_b32 v251, v23
    v_mov_b32 v252, v24
    v_mov_b32 v253, v25
    v_mov_b32 v254, v26
    v_mov_b32 v255, v27
L_ownt_3:
    v_add_f32 v108, v224, v232
    v_add_f32 v109, v225, v233
    v_add_f32 v110, v228, v236
    v_add_f32 v111, v229, v237
    v_add_f32 v108, v108, v240
    v_add_f32 v109, v109, v241
    v_add_f32 v110, v110, v244
    v_add_f32 v111, v111, v245
    v_add_f32 v108, v108, v248
    v_add_f32 v109, v109, v249
    v_add_f32 v110, v110, v252
    v_add_f32 v111, v111, v253
    s_branch L_final
L_notlast:
    buffer_store_dwordx4 v[20:23], v3, s[36:39], s82 offen sc1
    s_mov_b32 exec_lo, 3
    s_mov_b32 exec_hi, 3
    buffer_store_dwordx4 v[24:27], v4, s[36:39], s82 offen offset:1024 sc1
    s_mov_b64 exec, -1
    s_waitcnt vmcnt(0)
    s_barrier
    s_cmp_lg_u32 s48, 0
    s_cbranch_scc1 L_end
    s_mov_b64 exec, 1
    v_mov_b32 v192, 0x100
    buffer_atomic_add v192, v193, s[44:47], 0 offen
    s_mov_b64 exec, -1
    s_branch L_end
L_final:
    v_cvt_pk_bf16_f32 v106, v108, v109
    v_cvt_pk_bf16_f32 v107, v110, v111
    v_lshlrev_b32 v108, 16, v106
    v_and_b32 v109, 0xffff0000, v106
    v_lshlrev_b32 v110, 16, v107
    v_and_b32 v111, 0xffff0000, v107
    v_mul_f32 v116, v126, v108
    v_mul_f32 v117, v126, v110
    v_fma_f32 v116, v127, v109, v116
    v_fma_f32 v117, v127, v111, v117
    s_nop 0
    v_add_f32_dpp v116, v116, v116 quad_perm:[1,0,3,2] row_mask:0xf bank_mask:0xf
    v_add_f32_dpp v117, v117, v117 quad_perm:[1,0,3,2] row_mask:0xf bank_mask:0xf
    v_mov_b32 v106, v116
    v_mov_b32 v107, v117
    s_nop 0
    v_permlane32_swap_b32 v116, v106
    v_permlane32_swap_b32 v117, v107
    v_add_f32 v116, v116, v106
    v_add_f32 v117, v117, v107
    v_cvt_pk_bf16_f32 v106, v116, v117
    v_lshlrev_b32 v116, 16, v106
    v_and_b32 v117, 0xffff0000, v106
    v_add_f32 v117, s59, v117
    v_cvt_pk_bf16_f32 v106, v117, v117
    v_lshlrev_b32 v117, 16, v106
    v_div_scale_f32 v118, s[80:81], v117, v117, v116
    v_div_scale_f32 v119, vcc, v116, v117, v116
    v_rcp_f32 v120, v118
    s_nop 0
    v_fma_f32 v121, -v118, v120, 1.0
    v_fma_f32 v120, v121, v120, v120
    v_mul_f32 v121, v119, v120
    v_fma_f32 v122, -v118, v121, v119
    v_fma_f32 v121, v122, v120, v121
    v_fma_f32 v118, -v118, v121, v119
    v_div_fmas_f32 v118, v118, v120, v121
    v_div_fixup_f32 v118, v118, v117, v116
    v_cvt_pk_bf16_f32 v118, v118, v118
    s_lshl_b32 s3, s48, 1
    s_mov_b32 exec_lo, 0x55555555
    s_mov_b32 exec_hi, 0
    buffer_store_short v118, v124, s[40:43], s3 offen
    s_mov_b64 exec, -1
L_end:
    s_endpgm
.section .rodata,"a"
.p2align 6
.amdhsa_kernel standalone__linear_kernel_rfa__decode_kernel
  .amdhsa_next_free_vgpr 256
  .amdhsa_next_free_sgpr 102
  .amdhsa_accum_offset 256
  .amdhsa_group_segment_fixed_size 0
  .amdhsa_kernarg_size 56
  .amdhsa_user_sgpr_count 2
  .amdhsa_user_sgpr_kernarg_segment_ptr 1
  .amdhsa_system_sgpr_workgroup_id_x 1
  .amdhsa_float_denorm_mode_32 3
.end_amdhsa_kernel
```
